```python
import torch

def _softmax(x, axis=-1):
    return torch.softmax(x, dim=axis)
def _gelu(x):
    return torch.nn.functional.gelu(x, approximate="tanh")
def _silu(x):
    return torch.nn.functional.silu(x)
def _sigmoid(x):
    return torch.sigmoid(x)
def _layernorm(x, axis=-1, eps=1e-5):
    m = x.mean(dim=axis, keepdim=True)
    v = x.var(dim=axis, keepdim=True, unbiased=False)
    return (x - m) / torch.sqrt(v + eps)
def _scatter_add(tgt, idx, src, axis=0):
    return tgt.clone().index_add_(axis, idx, src)
def _segment_sum(src, seg, n):
    out = torch.zeros((n,) + src.shape[1:], dtype=src.dtype)
    return out.index_add_(0, seg, src)
def _pad(x, pw):
    flat = tuple(v for pair in reversed(pw) for v in pair)
    return torch.nn.functional.pad(x, flat)

kernel_name = 'sequential_preLN__ssm_conv_s4d__geglu_ffn__prompt'

def setup_inputs():

    _w = (lambda a: (lambda t: t.to(torch.bfloat16) if t.is_floating_point() else t)(torch.as_tensor(a)))
    def _A_setup():
        Bsz, L, D, N = 1, 2048, 512, 128
        return {
            "u": _w((lambda *s: torch.randn(*s, dtype=torch.bfloat16) * 0.05)(Bsz, L, D)),
            "log_A_real": _w((lambda *s: torch.randn(*s, dtype=torch.bfloat16) * 6.4)(D, N) * 0.5),
            "A_imag": _w((lambda *s: torch.randn(*s, dtype=torch.bfloat16) * 0.05)(D, N) * 3.14),
            "C_real": _w((lambda *s: torch.randn(*s, dtype=torch.bfloat16) * 0.05)(D, N) / N ** 0.5),
            "C_imag": _w((lambda *s: torch.randn(*s, dtype=torch.bfloat16) * 0.05)(D, N) / N ** 0.5),
            "log_dt": _w((lambda *s: torch.randn(*s, dtype=torch.bfloat16) * 0.05)(D) * 0.5 - 4.0),
            "D_skip": _w((lambda *s: torch.randn(*s, dtype=torch.bfloat16) * 0.05)(D)),
        }
    _A_in = _A_setup()

    def _B_setup():
        B, S, D, F = 1, 2048, 512, 1792
        return {
            "x": _w((lambda *s: torch.randn(*s, dtype=torch.bfloat16) * 0.05)(B, S, D)),
            "w_gate": _w((lambda *s: torch.randn(*s, dtype=torch.bfloat16) * 0.05)(D, F)),
            "w_up": _w((lambda *s: torch.randn(*s, dtype=torch.bfloat16) * 0.05)(D, F)),
            "w_down": _w((lambda *s: torch.randn(*s, dtype=torch.bfloat16) * 0.05)(F, D)),
        }
    _B_in = _B_setup()

    return {
        "A_u": _A_in["u"],
        "A_log_A_real": _A_in["log_A_real"],
        "A_A_imag": _A_in["A_imag"],
        "A_C_real": _A_in["C_real"],
        "A_C_imag": _A_in["C_imag"],
        "A_log_dt": _A_in["log_dt"],
        "A_D_skip": _A_in["D_skip"],
        "B_x": _B_in["x"],
        "B_w_gate": _B_in["w_gate"],
        "B_w_up": _B_in["w_up"],
        "B_w_down": _B_in["w_down"],
    }

def reference(A_u, A_log_A_real, A_A_imag, A_C_real, A_C_imag, A_log_dt, A_D_skip, B_x, B_w_gate, B_w_up, B_w_down):
    def _A_ref(u, log_A_real, A_imag, C_real, C_imag, log_dt, D_skip):
        L = u.shape[1]
        dt = torch.exp(log_dt)
        A = -torch.exp(log_A_real) + 1j * A_imag
        C = (C_real + 1j * C_imag) * dt[:, None]
        pos = (lambda x, dt: x.to(dt))(torch.arange(L), log_dt.dtype)
        P = torch.exp((A * dt[:, None])[:, :, None] * pos[None, None, :])
        K = 2.0 * torch.einsum("dn,dnl->dl", C, P).real
        L2 = 2 * L
        u_t = (lambda x, *d: x.permute(*d))(u, 0, 2, 1)
        Kf = (lambda x, *a, **k: torch.fft.rfft(x.float(), *a, **k))(K, L2)
        Uf = (lambda x, *a, **k: torch.fft.rfft(x.float(), *a, **k))(u_t, L2)
        y = (lambda x, *a, **k: torch.fft.irfft(x, *a, **k).to(torch.bfloat16))(Uf * Kf[None, :, :], L2)[:, :, :L]
        y = (lambda x, *d: x.permute(*d))(y, 0, 2, 1)
        return y + u * D_skip[None, None, :]

    def _B_ref(x, w_gate, w_up, w_down):
        return (_gelu(x @ w_gate) * (x @ w_up)) @ w_down

    x = A_u
    h = x + _A_ref(_layernorm(x, axis=-1), A_log_A_real, A_A_imag, A_C_real, A_C_imag, A_log_dt, A_D_skip)
    h2 = h + _B_ref(_layernorm(h, axis=-1), B_w_gate, B_w_up, B_w_down)
    return h2
```

```asm
; @launch grid=(256,1,1) block=(512,1,1) lds=163840
.amdgcn_target "amdgcn-amd-amdhsa--gfx950"
.text
.globl sequential_preLN__ssm_conv_s4d__geglu_ffn__prompt_kernel
.p2align 8
.type sequential_preLN__ssm_conv_s4d__geglu_ffn__prompt_kernel,@function
sequential_preLN__ssm_conv_s4d__geglu_ffn__prompt_kernel:
    s_cmp_ge_u32 s2, 256
    s_cbranch_scc1 L_end
    s_load_dwordx16 s[20:35], s[0:1], 0
    s_load_dwordx8 s[36:43], s[0:1], 64
    s_load_dwordx4 s[44:47], s[0:1], 96
    v_lshrrev_b32 v2, 6, v0
    v_mov_b32 v1, v0
    v_and_b32 v0, 63, v0
    v_readfirstlane_b32 s3, v2
    s_and_b32 s48, s2, 7
    s_lshr_b32 s49, s2, 3
    s_lshl_b32 s50, s48, 5
    s_add_u32 s50, s50, s49
    s_and_b32 s55, s48, 3
    s_lshl_b32 s55, s55, 2
    s_and_b32 s56, s49, 3
    s_add_u32 s51, s55, s56
    s_lshr_b32 s55, s48, 2
    s_lshl_b32 s55, s55, 3
    s_lshr_b32 s54, s49, 2
    s_add_u32 s52, s55, s54
    s_lshl_b32 s55, s48, 2
    s_add_u32 s53, s55, s56
    s_waitcnt lgkmcnt(0)
    s_mov_b32 s4, s46
    s_mov_b32 s5, s47
    s_mov_b32 s6, 16777216
    s_mov_b32 s7, 0x20000
    s_lshl_b32 s55, s50, 2
    s_load_dword s80, s[30:31], s55
    s_load_dword s81, s[32:33], s55
    s_load_dword s84, s[46:47], 0
    s_cmp_ge_u32 s3, 4
    s_cbranch_scc1 L_Upath_1
    s_or_b32 s56, s2, s3
    s_cmp_eq_u32 s56, 0
    s_cbranch_scc0 L_nozero_3
    v_lshlrev_b32 v16, 8, v0
    v_mov_b32 v17, 0
    s_mov_b32 s56, 266240
    buffer_store_dword v17, v16, s[4:7], s56 offen sc1
    v_and_b32 v16, 15, v0
    v_lshlrev_b32 v16, 8, v16
    s_mov_b32 s56, 282624
    buffer_store_dword v17, v16, s[4:7], s56 offen sc1
L_nozero_3:
    s_mov_b32 s8, s20
    s_mov_b32 s9, s21
    s_mov_b32 s10, 2097152
    s_mov_b32 s11, 0x20000
    s_lshl_b32 s56, s2, 2
    s_add_u32 s56, s56, s3
    s_lshl_b32 s56, s56, 11
    v_lshlrev_b32 v16, 4, v0
    buffer_load_dwordx4 v[4:7], v16, s[8:11], s56 offen
    buffer_load_dwordx4 v[8:11], v16, s[8:11], s56 offen offset:1024
    s_lshr_b32 s57, s3, 1
    s_lshl_b32 s58, s50, 1
    s_add_u32 s58, s58, s57
    s_lshl_b32 s58, s58, 8
    s_and_b32 s59, s3, 1
    s_lshl_b32 s59, s59, 7
    s_add_u32 s58, s58, s59
    v_lshlrev_b32 v17, 1, v0
    s_mov_b32 s12, s22
    s_mov_b32 s13, s23
    s_mov_b32 s14, 131072
    s_mov_b32 s15, 0x20000
    buffer_load_ushort v12, v17, s[12:15], s58 offen
    s_mov_b32 s12, s24
    s_mov_b32 s13, s25
    s_mov_b32 s14, 131072
    s_mov_b32 s15, 0x20000
    buffer_load_ushort v13, v17, s[12:15], s58 offen
    s_mov_b32 s12, s26
    s_mov_b32 s13, s27
    s_mov_b32 s14, 131072
    s_mov_b32 s15, 0x20000
    buffer_load_ushort v14, v17, s[12:15], s58 offen
    s_mov_b32 s12, s28
    s_mov_b32 s13, s29
    s_mov_b32 s14, 131072
    s_mov_b32 s15, 0x20000
    buffer_load_ushort v15, v17, s[12:15], s58 offen
    v_mov_b32 v18, 163776
    v_mov_b32 v19, 0
    v_mov_b32 v20, 0
    ds_write_b32 v18, v19 offset:0
    ds_write_b32 v18, v19 offset:4
    ds_write_b32 v18, v19 offset:8
    ds_write_b32 v18, v19 offset:12
    ds_write_b32 v18, v19 offset:16
    ds_write_b32 v18, v19 offset:20
    ds_write_b32 v18, v19 offset:24
    ds_write_b32 v18, v19 offset:28
    ds_write_b32 v18, v19 offset:32
    s_waitcnt lgkmcnt(0)
    s_barrier
    s_and_b32 s74, s2, 15
    s_mul_i32 s74, s74, 114688
    s_lshr_b32 s72, s2, 4
    s_mul_i32 s72, s72, 224
    s_add_u32 s74, s74, s72
    s_lshl_b32 s71, s3, 6
    v_add_u32 v30, s71, v0
    s_mov_b32 s73, 4682
    v_mul_lo_u32 v31, v30, s73
    v_lshrrev_b32 v31, 16, v31
    v_mul_u32_u24 v32, 14, v31
    v_sub_u32 v32, v30, v32
    s_mov_b32 s73, 3584
    v_mul_lo_u32 v31, v31, s73
    v_lshl_add_u32 v31, v32, 4, v31
    s_lshl_b32 s72, s71, 4
    s_mov_b32 s12, s36
    s_mov_b32 s13, s37
    s_mov_b32 s14, 1835008
    s_mov_b32 s15, 0x20000
    s_add_u32 m0, s72, 149248
    s_nop 0
    buffer_load_dwordx4 v31, s[12:15], s74 offen lds
    s_mov_b32 s12, s38
    s_mov_b32 s13, s39
    s_mov_b32 s14, 1835008
    s_mov_b32 s15, 0x20000
    s_add_u32 m0, s72, 156544
    s_nop 0
    buffer_load_dwordx4 v31, s[12:15], s74 offen lds
    s_cmp_eq_u32 s3, 3
    s_cbranch_scc1 L_q2_4
    s_lshl_b32 s71, s3, 6
    s_add_u32 s71, s71, 256
    v_add_u32 v30, s71, v0
    s_mov_b32 s73, 4682
    v_mul_lo_u32 v31, v30, s73
    v_lshrrev_b32 v31, 16, v31
    v_mul_u32_u24 v32, 14, v31
    v_sub_u32 v32, v30, v32
    s_mov_b32 s73, 3584
    v_mul_lo_u32 v31, v31, s73
    v_lshl_add_u32 v31, v32, 4, v31
    s_lshl_b32 s72, s71, 4
    s_mov_b32 s12, s36
    s_mov_b32 s13, s37
    s_mov_b32 s14, 1835008
    s_mov_b32 s15, 0x20000
    s_add_u32 m0, s72, 149248
    s_nop 0
    buffer_load_dwordx4 v31, s[12:15], s74 offen lds
    s_mov_b32 s12, s38
    s_mov_b32 s13, s39
    s_mov_b32 s14, 1835008
    s_mov_b32 s15, 0x20000
    s_add_u32 m0, s72, 156544
    s_nop 0
    buffer_load_dwordx4 v31, s[12:15], s74 offen lds
L_q2_4:
    s_mul_i32 s84, s84, 1664525
    s_add_u32 s84, s84, 1013904223
    s_cmp_eq_u32 s3, 3
    s_cbranch_scc1 L_w3_5
    s_waitcnt vmcnt(8)
    s_branch L_w3d_6
L_w3_5:
    s_waitcnt vmcnt(6)
L_w3d_6:
    v_mov_b32 v20, 0x3f803f80
    v_mov_b32 v16, 0
    v_mov_b32 v17, 0
    v_mov_b32 v18, 0
    v_mov_b32 v19, 0
    v_dot2_f32_bf16 v16, v4, v20, v16
    v_dot2_f32_bf16 v17, v4, v4, v17
    v_dot2_f32_bf16 v18, v8, v20, v18
    v_dot2_f32_bf16 v19, v8, v8, v19
    v_dot2_f32_bf16 v16, v5, v20, v16
    v_dot2_f32_bf16 v17, v5, v5, v17
    v_dot2_f32_bf16 v18, v9, v20, v18
    v_dot2_f32_bf16 v19, v9, v9, v19
    v_dot2_f32_bf16 v16, v6, v20, v16
    v_dot2_f32_bf16 v17, v6, v6, v17
    v_dot2_f32_bf16 v18, v10, v20, v18
    v_dot2_f32_bf16 v19, v10, v10, v19
    v_dot2_f32_bf16 v16, v7, v20, v16
    v_dot2_f32_bf16 v17, v7, v7, v17
    v_dot2_f32_bf16 v18, v11, v20, v18
    v_dot2_f32_bf16 v19, v11, v11, v19
    v_add_f32_dpp v16, v16, v16 row_shr:1 row_mask:0xf bank_mask:0xf
    v_add_f32_dpp v17, v17, v17 row_shr:1 row_mask:0xf bank_mask:0xf
    v_add_f32_dpp v18, v18, v18 row_shr:1 row_mask:0xf bank_mask:0xf
    v_add_f32_dpp v19, v19, v19 row_shr:1 row_mask:0xf bank_mask:0xf
    v_add_f32_dpp v16, v16, v16 row_shr:2 row_mask:0xf bank_mask:0xf
    v_add_f32_dpp v17, v17, v17 row_shr:2 row_mask:0xf bank_mask:0xf
    v_add_f32_dpp v18, v18, v18 row_shr:2 row_mask:0xf bank_mask:0xf
    v_add_f32_dpp v19, v19, v19 row_shr:2 row_mask:0xf bank_mask:0xf
    v_add_f32_dpp v16, v16, v16 row_shr:4 row_mask:0xf bank_mask:0xf
    v_add_f32_dpp v17, v17, v17 row_shr:4 row_mask:0xf bank_mask:0xf
    v_add_f32_dpp v18, v18, v18 row_shr:4 row_mask:0xf bank_mask:0xf
    v_add_f32_dpp v19, v19, v19 row_shr:4 row_mask:0xf bank_mask:0xf
    v_add_f32_dpp v16, v16, v16 row_shr:8 row_mask:0xf bank_mask:0xf
    v_add_f32_dpp v17, v17, v17 row_shr:8 row_mask:0xf bank_mask:0xf
    v_add_f32_dpp v18, v18, v18 row_shr:8 row_mask:0xf bank_mask:0xf
    v_add_f32_dpp v19, v19, v19 row_shr:8 row_mask:0xf bank_mask:0xf
    v_add_f32_dpp v16, v16, v16 row_bcast:15 row_mask:0xa bank_mask:0xf
    v_add_f32_dpp v17, v17, v17 row_bcast:15 row_mask:0xa bank_mask:0xf
    v_add_f32_dpp v18, v18, v18 row_bcast:15 row_mask:0xa bank_mask:0xf
    v_add_f32_dpp v19, v19, v19 row_bcast:15 row_mask:0xa bank_mask:0xf
    v_add_f32_dpp v16, v16, v16 row_bcast:31 row_mask:0xc bank_mask:0xf
    v_add_f32_dpp v17, v17, v17 row_bcast:31 row_mask:0xc bank_mask:0xf
    v_add_f32_dpp v18, v18, v18 row_bcast:31 row_mask:0xc bank_mask:0xf
    v_add_f32_dpp v19, v19, v19 row_bcast:31 row_mask:0xc bank_mask:0xf
    v_mul_f32 v16, 0x3b000000, v16
    v_mul_f32 v18, 0x3b000000, v18
    v_mul_f32 v17, 0x3b000000, v17
    v_mul_f32 v19, 0x3b000000, v19
    v_fma_f32 v17, -v16, v16, v17
    v_fma_f32 v19, -v18, v18, v19
    v_max_f32 v17, 0, v17
    v_max_f32 v19, 0, v19
    v_cvt_pk_bf16_f32 v21, v17, v17
    v_cvt_pk_bf16_f32 v22, v19, v19
    v_lshlrev_b32 v21, 16, v21
    v_lshlrev_b32 v22, 16, v22
    v_add_f32 v21, 0x3727c5ac, v21
    v_add_f32 v22, 0x3727c5ac, v22
    v_cvt_pk_bf16_f32 v21, v21, v21
    v_cvt_pk_bf16_f32 v22, v22, v22
    v_lshlrev_b32 v21, 16, v21
    v_lshlrev_b32 v22, 16, v22
    v_sqrt_f32 v21, v21
    v_sqrt_f32 v22, v22
    v_cvt_pk_bf16_f32 v21, v21, v21
    v_cvt_pk_bf16_f32 v22, v22, v22
    v_lshlrev_b32 v17, 16, v21
    v_lshlrev_b32 v19, 16, v22
    v_cvt_pk_bf16_f32 v24, v16, v17
    v_cvt_pk_bf16_f32 v26, v18, v19
    v_mov_b32 v25, s84
    v_mov_b32 v27, s84
    s_lshl_b32 s56, s2, 2
    s_add_u32 s56, s56, s3
    s_lshl_b32 s56, s56, 4
    s_add_u32 s56, s56, 16384
    v_mov_b32 v21, 0
    s_mov_b64 s[90:91], exec
    s_mov_b32 exec_lo, 0
    s_mov_b32 exec_hi, 0x80000000
    buffer_store_dwordx4 v[24:27], v21, s[4:7], s56 offen sc1
    s_mov_b64 exec, s[90:91]
    v_mov_b32 v30, 163788
    v_mov_b32 v31, 1
    s_mov_b64 s[90:91], exec
    s_mov_b64 exec, 1
    ds_add_u32 v30, v31
    s_mov_b64 exec, s[90:91]
    s_cmp_eq_u32 s3, 3
    s_cbranch_scc1 L_w3_7
    s_waitcnt vmcnt(5)
    s_branch L_w3d_8
L_w3_7:
    s_waitcnt vmcnt(3)
L_w3d_8:
    v_lshlrev_b32 v12, 16, v12
    v_lshlrev_b32 v13, 16, v13
    v_lshlrev_b32 v14, 16, v14
    v_lshlrev_b32 v15, 16, v15
    s_lshl_b32 s58, s80, 16
    s_and_b32 s59, s80, 0xffff0000
    s_cmp_eq_u32 s57, 0
    s_cselect_b32 s58, s58, s59
    v_mov_b32 v16, 1069066811
    v_mul_f32 v12, v12, v16
    v_mul_f32 v16, s58, v16
    v_exp_f32 v12, v12
    v_exp_f32 v16, v16
    s_nop 0
    v_cvt_pk_bf16_f32 v19, v12, v16
    v_lshlrev_b32 v12, 16, v19
    v_and_b32 v16, 0xffff0000, v19
    v_mul_f32 v17, v12, v16
    v_mul_f32 v18, v13, v16
    v_mul_f32 v17, 0xbfb8aa3b, v17
    v_mul_f32 v18, 0x3e22f983, v18
    v_add_f32 v16, v16, v16
    v_mul_f32 v14, v14, v16
    v_mul_f32 v15, v15, v16
    v_mul_f32 v44, 0x42000000, v17
    v_mul_f32 v48, 0x42000000, v18
    v_mul_f32 v45, 1.0, v17
    v_mul_f32 v49, 1.0, v18
    v_mul_f32 v46, 0x41800000, v17
    v_mul_f32 v50, 0x41800000, v18
    v_mul_f32 v47, 0x44800000, v17
    v_mul_f32 v51, 0x44800000, v18
    v_exp_f32 v44, v44
    v_fract_f32 v48, v48
    v_exp_f32 v45, v45
    v_fract_f32 v49, v49
    v_exp_f32 v46, v46
    v_fract_f32 v50, v50
    v_exp_f32 v47, v47
    v_fract_f32 v51, v51
    v_cos_f32 v20, v48
    v_sin_f32 v21, v48
    v_cos_f32 v24, v49
    v_sin_f32 v25, v49
    v_cos_f32 v40, v50
    v_sin_f32 v41, v50
    v_cos_f32 v34, v51
    v_sin_f32 v35, v51
    v_mul_f32 v20, v20, v44
    v_mul_f32_e64 v21, -v21, v44
    v_mul_f32 v24, v24, v45
    v_mul_f32 v25, v25, v45
    v_mul_f32 v40, v40, v46
    v_mul_f32 v41, v41, v46
    v_mul_f32 v34, v34, v47
    v_mul_f32_e64 v35, -v35, v47
    v_sub_f32 v22, 0, v21
    v_mov_b32 v23, v20
    v_sub_f32 v26, 0, v25
    v_mov_b32 v27, v24
    v_mul_f32 v32, v14, v34
    v_mul_f32 v33, v14, v35
    v_fmac_f32 v32, v15, v35
    v_fma_f32 v33, -v15, v34, v33
    v_mov_b32 v28, v14
    v_sub_f32 v29, 0, v15
    v_mov_b32 v36, 1.0
    v_mov_b32 v37, 0
    s_mul_i32 s63, s57, 54080
    s_and_b32 s64, s3, 1
    s_lshl_b32 s64, s64, 8
    s_add_u32 s64, s63, s64
    s_mov_b32 m0, s64
    v_pk_mul_f32 v[58:59], v[28:29], v[22:23] op_sel:[1,0] op_sel_hi:[1,1]
    v_pk_mul_f32 v[60:61], v[32:33], v[22:23] op_sel:[1,0] op_sel_hi:[1,1]
    v_pk_mul_f32 v[62:63], v[36:37], v[26:27] op_sel:[1,0] op_sel_hi:[1,1]
    v_cvt_pk_bf16_f32 v54, v28, v29
    v_cvt_pk_bf16_f32 v55, v32, v33
    v_cvt_pk_bf16_f32 v56, v36, v37
    v_pk_fma_f32 v[30:31], v[28:29], v[20:21], v[58:59] op_sel:[0,0,0] op_sel_hi:[0,1,1]
    v_pk_fma_f32 v[34:35], v[32:33], v[20:21], v[60:61] op_sel:[0,0,0] op_sel_hi:[0,1,1]
    v_pk_fma_f32 v[38:39], v[36:37], v[24:25], v[62:63] op_sel:[0,0,0] op_sel_hi:[0,1,1]
    ds_write_addtid_b32 v54 offset:19264
    ds_write_addtid_b32 v55 offset:36672
    ds_write_addtid_b32 v56 offset:0
    v_pk_mul_f32 v[58:59], v[30:31], v[22:23] op_sel:[1,0] op_sel_hi:[1,1]
    v_pk_mul_f32 v[60:61], v[34:35], v[22:23] op_sel:[1,0] op_sel_hi:[1,1]
    v_pk_mul_f32 v[62:63], v[40:41], v[26:27] op_sel:[1,0] op_sel_hi:[1,1]
    v_cvt_pk_bf16_f32 v54, v30, v31
    v_cvt_pk_bf16_f32 v55, v34, v35
    v_cvt_pk_bf16_f32 v56, v40, v41
    v_pk_fma_f32 v[28:29], v[30:31], v[20:21], v[58:59] op_sel:[0,0,0] op_sel_hi:[0,1,1]
    v_pk_fma_f32 v[32:33], v[34:35], v[20:21], v[60:61] op_sel:[0,0,0] op_sel_hi:[0,1,1]
    v_pk_fma_f32 v[42:43], v[40:41], v[24:25], v[62:63] op_sel:[0,0,0] op_sel_hi:[0,1,1]
    ds_write_addtid_b32 v54 offset:19808
    ds_write_addtid_b32 v55 offset:37216
    ds_write_addtid_b32 v56 offset:9376
    v_pk_mul_f32 v[58:59], v[28:29], v[22:23] op_sel:[1,0] op_sel_hi:[1,1]
    v_pk_mul_f32 v[60:61], v[32:33], v[22:23] op_sel:[1,0] op_sel_hi:[1,1]
    v_pk_mul_f32 v[62:63], v[38:39], v[26:27] op_sel:[1,0] op_sel_hi:[1,1]
    v_cvt_pk_bf16_f32 v54, v28, v29
    v_cvt_pk_bf16_f32 v55, v32, v33
    v_cvt_pk_bf16_f32 v56, v38, v39
    v_pk_fma_f32 v[30:31], v[28:29], v[20:21], v[58:59] op_sel:[0,0,0] op_sel_hi:[0,1,1]
    v_pk_fma_f32 v[34:35], v[32:33], v[20:21], v[60:61] op_sel:[0,0,0] op_sel_hi:[0,1,1]
    v_pk_fma_f32 v[36:37], v[38:39], v[24:25], v[62:63] op_sel:[0,0,0] op_sel_hi:[0,1,1]
    ds_write_addtid_b32 v54 offset:20352
    ds_write_addtid_b32 v55 offset:37760
    ds_write_addtid_b32 v56 offset:576
    v_pk_mul_f32 v[58:59], v[30:31], v[22:23] op_sel:[1,0] op_sel_hi:[1,1]
    v_pk_mul_f32 v[60:61], v[34:35], v[22:23] op_sel:[1,0] op_sel_hi:[1,1]
    v_pk_mul_f32 v[62:63], v[42:43], v[26:27] op_sel:[1,0] op_sel_hi:[1,1]
    v_cvt_pk_bf16_f32 v54, v30, v31
    v_cvt_pk_bf16_f32 v55, v34, v35
    v_cvt_pk_bf16_f32 v56, v42, v43
    v_pk_fma_f32 v[28:29], v[30:31], v[20:21], v[58:59] op_sel:[0,0,0] op_sel_hi:[0,1,1]
    v_pk_fma_f32 v[32:33], v[34:35], v[20:21], v[60:61] op_sel:[0,0,0] op_sel_hi:[0,1,1]
    v_pk_fma_f32 v[40:41], v[42:43], v[24:25], v[62:63] op_sel:[0,0,0] op_sel_hi:[0,1,1]
    ds_write_addtid_b32 v54 offset:20896
    ds_write_addtid_b32 v55 offset:38304
    ds_write_addtid_b32 v56 offset:9952
    v_pk_mul_f32 v[58:59], v[28:29], v[22:23] op_sel:[1,0] op_sel_hi:[1,1]
    v_pk_mul_f32 v[60:61], v[32:33], v[22:23] op_sel:[1,0] op_sel_hi:[1,1]
    v_pk_mul_f32 v[62:63], v[36:37], v[26:27] op_sel:[1,0] op_sel_hi:[1,1]
    v_cvt_pk_bf16_f32 v54, v28, v29
    v_cvt_pk_bf16_f32 v55, v32, v33
    v_cvt_pk_bf16_f32 v56, v36, v37
    v_pk_fma_f32 v[30:31], v[28:29], v[20:21], v[58:59] op_sel:[0,0,0] op_sel_hi:[0,1,1]
    v_pk_fma_f32 v[34:35], v[32:33], v[20:21], v[60:61] op_sel:[0,0,0] op_sel_hi:[0,1,1]
    v_pk_fma_f32 v[38:39], v[36:37], v[24:25], v[62:63] op_sel:[0,0,0] op_sel_hi:[0,1,1]
    ds_write_addtid_b32 v54 offset:21440
    ds_write_addtid_b32 v55 offset:38848
    ds_write_addtid_b32 v56 offset:1152
    v_pk_mul_f32 v[58:59], v[30:31], v[22:23] op_sel:[1,0] op_sel_hi:[1,1]
    v_pk_mul_f32 v[60:61], v[34:35], v[22:23] op_sel:[1,0] op_sel_hi:[1,1]
    v_pk_mul_f32 v[62:63], v[40:41], v[26:27] op_sel:[1,0] op_sel_hi:[1,1]
    v_cvt_pk_bf16_f32 v54, v30, v31
    v_cvt_pk_bf16_f32 v55, v34, v35
    v_cvt_pk_bf16_f32 v56, v40, v41
    v_pk_fma_f32 v[28:29], v[30:31], v[20:21], v[58:59] op_sel:[0,0,0] op_sel_hi:[0,1,1]
    v_pk_fma_f32 v[32:33], v[34:35], v[20:21], v[60:61] op_sel:[0,0,0] op_sel_hi:[0,1,1]
    v_pk_fma_f32 v[42:43], v[40:41], v[24:25], v[62:63] op_sel:[0,0,0] op_sel_hi:[0,1,1]
    ds_write_addtid_b32 v54 offset:21984
    ds_write_addtid_b32 v55 offset:39392
    ds_write_addtid_b32 v56 offset:10528
    v_pk_mul_f32 v[58:59], v[28:29], v[22:23] op_sel:[1,0] op_sel_hi:[1,1]
    v_pk_mul_f32 v[60:61], v[32:33], v[22:23] op_sel:[1,0] op_sel_hi:[1,1]
    v_pk_mul_f32 v[62:63], v[38:39], v[26:27] op_sel:[1,0] op_sel_hi:[1,1]
    v_cvt_pk_bf16_f32 v54, v28, v29
    v_cvt_pk_bf16_f32 v55, v32, v33
    v_cvt_pk_bf16_f32 v56, v38, v39
    v_pk_fma_f32 v[30:31], v[28:29], v[20:21], v[58:59] op_sel:[0,0,0] op_sel_hi:[0,1,1]
    v_pk_fma_f32 v[34:35], v[32:33], v[20:21], v[60:61] op_sel:[0,0,0] op_sel_hi:[0,1,1]
    v_pk_fma_f32 v[36:37], v[38:39], v[24:25], v[62:63] op_sel:[0,0,0] op_sel_hi:[0,1,1]
    ds_write_addtid_b32 v54 offset:22528
    ds_write_addtid_b32 v55 offset:39936
    ds_write_addtid_b32 v56 offset:1728
    v_pk_mul_f32 v[58:59], v[30:31], v[22:23] op_sel:[1,0] op_sel_hi:[1,1]
    v_pk_mul_f32 v[60:61], v[34:35], v[22:23] op_sel:[1,0] op_sel_hi:[1,1]
    v_pk_mul_f32 v[62:63], v[42:43], v[26:27] op_sel:[1,0] op_sel_hi:[1,1]
    v_cvt_pk_bf16_f32 v54, v30, v31
    v_cvt_pk_bf16_f32 v55, v34, v35
    v_cvt_pk_bf16_f32 v56, v42, v43
    v_pk_fma_f32 v[28:29], v[30:31], v[20:21], v[58:59] op_sel:[0,0,0] op_sel_hi:[0,1,1]
    v_pk_fma_f32 v[32:33], v[34:35], v[20:21], v[60:61] op_sel:[0,0,0] op_sel_hi:[0,1,1]
    v_pk_fma_f32 v[40:41], v[42:43], v[24:25], v[62:63] op_sel:[0,0,0] op_sel_hi:[0,1,1]
    ds_write_addtid_b32 v54 offset:23072
    ds_write_addtid_b32 v55 offset:40480
    ds_write_addtid_b32 v56 offset:11104
    v_pk_mul_f32 v[58:59], v[28:29], v[22:23] op_sel:[1,0] op_sel_hi:[1,1]
    v_pk_mul_f32 v[60:61], v[32:33], v[22:23] op_sel:[1,0] op_sel_hi:[1,1]
    v_pk_mul_f32 v[62:63], v[36:37], v[26:27] op_sel:[1,0] op_sel_hi:[1,1]
    v_cvt_pk_bf16_f32 v54, v28, v29
    v_cvt_pk_bf16_f32 v55, v32, v33
    v_cvt_pk_bf16_f32 v56, v36, v37
    v_pk_fma_f32 v[30:31], v[28:29], v[20:21], v[58:59] op_sel:[0,0,0] op_sel_hi:[0,1,1]
    v_pk_fma_f32 v[34:35], v[32:33], v[20:21], v[60:61] op_sel:[0,0,0] op_sel_hi:[0,1,1]
    v_pk_fma_f32 v[38:39], v[36:37], v[24:25], v[62:63] op_sel:[0,0,0] op_sel_hi:[0,1,1]
    ds_write_addtid_b32 v54 offset:23616
    ds_write_addtid_b32 v55 offset:41024
    ds_write_addtid_b32 v56 offset:2336
    v_pk_mul_f32 v[58:59], v[30:31], v[22:23] op_sel:[1,0] op_sel_hi:[1,1]
    v_pk_mul_f32 v[60:61], v[34:35], v[22:23] op_sel:[1,0] op_sel_hi:[1,1]
    v_pk_mul_f32 v[62:63], v[40:41], v[26:27] op_sel:[1,0] op_sel_hi:[1,1]
    v_cvt_pk_bf16_f32 v54, v30, v31
    v_cvt_pk_bf16_f32 v55, v34, v35
    v_cvt_pk_bf16_f32 v56, v40, v41
    v_pk_fma_f32 v[28:29], v[30:31], v[20:21], v[58:59] op_sel:[0,0,0] op_sel_hi:[0,1,1]
    v_pk_fma_f32 v[32:33], v[34:35], v[20:21], v[60:61] op_sel:[0,0,0] op_sel_hi:[0,1,1]
    v_pk_fma_f32 v[42:43], v[40:41], v[24:25], v[62:63] op_sel:[0,0,0] op_sel_hi:[0,1,1]
    ds_write_addtid_b32 v54 offset:24160
    ds_write_addtid_b32 v55 offset:41568
    ds_write_addtid_b32 v56 offset:11712
    v_pk_mul_f32 v[58:59], v[28:29], v[22:23] op_sel:[1,0] op_sel_hi:[1,1]
    v_pk_mul_f32 v[60:61], v[32:33], v[22:23] op_sel:[1,0] op_sel_hi:[1,1]
    v_pk_mul_f32 v[62:63], v[38:39], v[26:27] op_sel:[1,0] op_sel_hi:[1,1]
    v_cvt_pk_bf16_f32 v54, v28, v29
    v_cvt_pk_bf16_f32 v55, v32, v33
    v_cvt_pk_bf16_f32 v56, v38, v39
    v_pk_fma_f32 v[30:31], v[28:29], v[20:21], v[58:59] op_sel:[0,0,0] op_sel_hi:[0,1,1]
    v_pk_fma_f32 v[34:35], v[32:33], v[20:21], v[60:61] op_sel:[0,0,0] op_sel_hi:[0,1,1]
    v_pk_fma_f32 v[36:37], v[38:39], v[24:25], v[62:63] op_sel:[0,0,0] op_sel_hi:[0,1,1]
    ds_write_addtid_b32 v54 offset:24704
    ds_write_addtid_b32 v55 offset:42112
    ds_write_addtid_b32 v56 offset:2912
    v_pk_mul_f32 v[58:59], v[30:31], v[22:23] op_sel:[1,0] op_sel_hi:[1,1]
    v_pk_mul_f32 v[60:61], v[34:35], v[22:23] op_sel:[1,0] op_sel_hi:[1,1]
    v_pk_mul_f32 v[62:63], v[42:43], v[26:27] op_sel:[1,0] op_sel_hi:[1,1]
    v_cvt_pk_bf16_f32 v54, v30, v31
    v_cvt_pk_bf16_f32 v55, v34, v35
    v_cvt_pk_bf16_f32 v56, v42, v43
    v_pk_fma_f32 v[28:29], v[30:31], v[20:21], v[58:59] op_sel:[0,0,0] op_sel_hi:[0,1,1]
    v_pk_fma_f32 v[32:33], v[34:35], v[20:21], v[60:61] op_sel:[0,0,0] op_sel_hi:[0,1,1]
    v_pk_fma_f32 v[40:41], v[42:43], v[24:25], v[62:63] op_sel:[0,0,0] op_sel_hi:[0,1,1]
    ds_write_addtid_b32 v54 offset:25248
    ds_write_addtid_b32 v55 offset:42656
    ds_write_addtid_b32 v56 offset:12288
    v_pk_mul_f32 v[58:59], v[28:29], v[22:23] op_sel:[1,0] op_sel_hi:[1,1]
    v_pk_mul_f32 v[60:61], v[32:33], v[22:23] op_sel:[1,0] op_sel_hi:[1,1]
    v_pk_mul_f32 v[62:63], v[36:37], v[26:27] op_sel:[1,0] op_sel_hi:[1,1]
    v_cvt_pk_bf16_f32 v54, v28, v29
    v_cvt_pk_bf16_f32 v55, v32, v33
    v_cvt_pk_bf16_f32 v56, v36, v37
    v_pk_fma_f32 v[30:31], v[28:29], v[20:21], v[58:59] op_sel:[0,0,0] op_sel_hi:[0,1,1]
    v_pk_fma_f32 v[34:35], v[32:33], v[20:21], v[60:61] op_sel:[0,0,0] op_sel_hi:[0,1,1]
    v_pk_fma_f32 v[38:39], v[36:37], v[24:25], v[62:63] op_sel:[0,0,0] op_sel_hi:[0,1,1]
    ds_write_addtid_b32 v54 offset:25792
    ds_write_addtid_b32 v55 offset:43200
    ds_write_addtid_b32 v56 offset:3488
    v_pk_mul_f32 v[58:59], v[30:31], v[22:23] op_sel:[1,0] op_sel_hi:[1,1]
    v_pk_mul_f32 v[60:61], v[34:35], v[22:23] op_sel:[1,0] op_sel_hi:[1,1]
    v_pk_mul_f32 v[62:63], v[40:41], v[26:27] op_sel:[1,0] op_sel_hi:[1,1]
    v_cvt_pk_bf16_f32 v54, v30, v31
    v_cvt_pk_bf16_f32 v55, v34, v35
    v_cvt_pk_bf16_f32 v56, v40, v41
    v_pk_fma_f32 v[28:29], v[30:31], v[20:21], v[58:59] op_sel:[0,0,0] op_sel_hi:[0,1,1]
    v_pk_fma_f32 v[32:33], v[34:35], v[20:21], v[60:61] op_sel:[0,0,0] op_sel_hi:[0,1,1]
    v_pk_fma_f32 v[42:43], v[40:41], v[24:25], v[62:63] op_sel:[0,0,0] op_sel_hi:[0,1,1]
    ds_write_addtid_b32 v54 offset:26336
    ds_write_addtid_b32 v55 offset:43744
    ds_write_addtid_b32 v56 offset:12864
    v_pk_mul_f32 v[58:59], v[28:29], v[22:23] op_sel:[1,0] op_sel_hi:[1,1]
    v_pk_mul_f32 v[60:61], v[32:33], v[22:23] op_sel:[1,0] op_sel_hi:[1,1]
    v_pk_mul_f32 v[62:63], v[38:39], v[26:27] op_sel:[1,0] op_sel_hi:[1,1]
    v_cvt_pk_bf16_f32 v54, v28, v29
    v_cvt_pk_bf16_f32 v55, v32, v33
    v_cvt_pk_bf16_f32 v56, v38, v39
    v_pk_fma_f32 v[30:31], v[28:29], v[20:21], v[58:59] op_sel:[0,0,0] op_sel_hi:[0,1,1]
    v_pk_fma_f32 v[34:35], v[32:33], v[20:21], v[60:61] op_sel:[0,0,0] op_sel_hi:[0,1,1]
    v_pk_fma_f32 v[36:37], v[38:39], v[24:25], v[62:63] op_sel:[0,0,0] op_sel_hi:[0,1,1]
    ds_write_addtid_b32 v54 offset:26880
    ds_write_addtid_b32 v55 offset:44288
    ds_write_addtid_b32 v56 offset:4064
    v_pk_mul_f32 v[58:59], v[30:31], v[22:23] op_sel:[1,0] op_sel_hi:[1,1]
    v_pk_mul_f32 v[60:61], v[34:35], v[22:23] op_sel:[1,0] op_sel_hi:[1,1]
    v_pk_mul_f32 v[62:63], v[42:43], v[26:27] op_sel:[1,0] op_sel_hi:[1,1]
    v_cvt_pk_bf16_f32 v54, v30, v31
    v_cvt_pk_bf16_f32 v55, v34, v35
    v_cvt_pk_bf16_f32 v56, v42, v43
    v_pk_fma_f32 v[28:29], v[30:31], v[20:21], v[58:59] op_sel:[0,0,0] op_sel_hi:[0,1,1]
    v_pk_fma_f32 v[32:33], v[34:35], v[20:21], v[60:61] op_sel:[0,0,0] op_sel_hi:[0,1,1]
    v_pk_fma_f32 v[40:41], v[42:43], v[24:25], v[62:63] op_sel:[0,0,0] op_sel_hi:[0,1,1]
    ds_write_addtid_b32 v54 offset:27424
    ds_write_addtid_b32 v55 offset:44832
    ds_write_addtid_b32 v56 offset:13440
    v_pk_mul_f32 v[58:59], v[28:29], v[22:23] op_sel:[1,0] op_sel_hi:[1,1]
    v_pk_mul_f32 v[60:61], v[32:33], v[22:23] op_sel:[1,0] op_sel_hi:[1,1]
    v_pk_mul_f32 v[62:63], v[36:37], v[26:27] op_sel:[1,0] op_sel_hi:[1,1]
    v_cvt_pk_bf16_f32 v54, v28, v29
    v_cvt_pk_bf16_f32 v55, v32, v33
    v_cvt_pk_bf16_f32 v56, v36, v37
    v_pk_fma_f32 v[30:31], v[28:29], v[20:21], v[58:59] op_sel:[0,0,0] op_sel_hi:[0,1,1]
    v_pk_fma_f32 v[34:35], v[32:33], v[20:21], v[60:61] op_sel:[0,0,0] op_sel_hi:[0,1,1]
    v_pk_fma_f32 v[38:39], v[36:37], v[24:25], v[62:63] op_sel:[0,0,0] op_sel_hi:[0,1,1]
    ds_write_addtid_b32 v54 offset:27968
    ds_write_addtid_b32 v55 offset:45376
    ds_write_addtid_b32 v56 offset:4672
    v_pk_mul_f32 v[58:59], v[30:31], v[22:23] op_sel:[1,0] op_sel_hi:[1,1]
    v_pk_mul_f32 v[60:61], v[34:35], v[22:23] op_sel:[1,0] op_sel_hi:[1,1]
    v_pk_mul_f32 v[62:63], v[40:41], v[26:27] op_sel:[1,0] op_sel_hi:[1,1]
    v_cvt_pk_bf16_f32 v54, v30, v31
    v_cvt_pk_bf16_f32 v55, v34, v35
    v_cvt_pk_bf16_f32 v56, v40, v41
    v_pk_fma_f32 v[28:29], v[30:31], v[20:21], v[58:59] op_sel:[0,0,0] op_sel_hi:[0,1,1]
    v_pk_fma_f32 v[32:33], v[34:35], v[20:21], v[60:61] op_sel:[0,0,0] op_sel_hi:[0,1,1]
    v_pk_fma_f32 v[42:43], v[40:41], v[24:25], v[62:63] op_sel:[0,0,0] op_sel_hi:[0,1,1]
    ds_write_addtid_b32 v54 offset:28512
    ds_write_addtid_b32 v55 offset:45920
    ds_write_addtid_b32 v56 offset:14048
    v_pk_mul_f32 v[58:59], v[28:29], v[22:23] op_sel:[1,0] op_sel_hi:[1,1]
    v_pk_mul_f32 v[60:61], v[32:33], v[22:23] op_sel:[1,0] op_sel_hi:[1,1]
    v_pk_mul_f32 v[62:63], v[38:39], v[26:27] op_sel:[1,0] op_sel_hi:[1,1]
    v_cvt_pk_bf16_f32 v54, v28, v29
    v_cvt_pk_bf16_f32 v55, v32, v33
    v_cvt_pk_bf16_f32 v56, v38, v39
    v_pk_fma_f32 v[30:31], v[28:29], v[20:21], v[58:59] op_sel:[0,0,0] op_sel_hi:[0,1,1]
    v_pk_fma_f32 v[34:35], v[32:33], v[20:21], v[60:61] op_sel:[0,0,0] op_sel_hi:[0,1,1]
    v_pk_fma_f32 v[36:37], v[38:39], v[24:25], v[62:63] op_sel:[0,0,0] op_sel_hi:[0,1,1]
    ds_write_addtid_b32 v54 offset:29056
    ds_write_addtid_b32 v55 offset:46464
    ds_write_addtid_b32 v56 offset:5248
    v_pk_mul_f32 v[58:59], v[30:31], v[22:23] op_sel:[1,0] op_sel_hi:[1,1]
    v_pk_mul_f32 v[60:61], v[34:35], v[22:23] op_sel:[1,0] op_sel_hi:[1,1]
    v_pk_mul_f32 v[62:63], v[42:43], v[26:27] op_sel:[1,0] op_sel_hi:[1,1]
    v_cvt_pk_bf16_f32 v54, v30, v31
    v_cvt_pk_bf16_f32 v55, v34, v35
    v_cvt_pk_bf16_f32 v56, v42, v43
    v_pk_fma_f32 v[28:29], v[30:31], v[20:21], v[58:59] op_sel:[0,0,0] op_sel_hi:[0,1,1]
    v_pk_fma_f32 v[32:33], v[34:35], v[20:21], v[60:61] op_sel:[0,0,0] op_sel_hi:[0,1,1]
    v_pk_fma_f32 v[40:41], v[42:43], v[24:25], v[62:63] op_sel:[0,0,0] op_sel_hi:[0,1,1]
    ds_write_addtid_b32 v54 offset:29600
    ds_write_addtid_b32 v55 offset:47008
    ds_write_addtid_b32 v56 offset:14624
    v_pk_mul_f32 v[58:59], v[28:29], v[22:23] op_sel:[1,0] op_sel_hi:[1,1]
    v_pk_mul_f32 v[60:61], v[32:33], v[22:23] op_sel:[1,0] op_sel_hi:[1,1]
    v_pk_mul_f32 v[62:63], v[36:37], v[26:27] op_sel:[1,0] op_sel_hi:[1,1]
    v_cvt_pk_bf16_f32 v54, v28, v29
    v_cvt_pk_bf16_f32 v55, v32, v33
    v_cvt_pk_bf16_f32 v56, v36, v37
    v_pk_fma_f32 v[30:31], v[28:29], v[20:21], v[58:59] op_sel:[0,0,0] op_sel_hi:[0,1,1]
    v_pk_fma_f32 v[34:35], v[32:33], v[20:21], v[60:61] op_sel:[0,0,0] op_sel_hi:[0,1,1]
    v_pk_fma_f32 v[38:39], v[36:37], v[24:25], v[62:63] op_sel:[0,0,0] op_sel_hi:[0,1,1]
    ds_write_addtid_b32 v54 offset:30144
    ds_write_addtid_b32 v55 offset:47552
    ds_write_addtid_b32 v56 offset:5824
    v_pk_mul_f32 v[58:59], v[30:31], v[22:23] op_sel:[1,0] op_sel_hi:[1,1]
    v_pk_mul_f32 v[60:61], v[34:35], v[22:23] op_sel:[1,0] op_sel_hi:[1,1]
    v_pk_mul_f32 v[62:63], v[40:41], v[26:27] op_sel:[1,0] op_sel_hi:[1,1]
    v_cvt_pk_bf16_f32 v54, v30, v31
    v_cvt_pk_bf16_f32 v55, v34, v35
    v_cvt_pk_bf16_f32 v56, v40, v41
    v_pk_fma_f32 v[28:29], v[30:31], v[20:21], v[58:59] op_sel:[0,0,0] op_sel_hi:[0,1,1]
    v_pk_fma_f32 v[32:33], v[34:35], v[20:21], v[60:61] op_sel:[0,0,0] op_sel_hi:[0,1,1]
    v_pk_fma_f32 v[42:43], v[40:41], v[24:25], v[62:63] op_sel:[0,0,0] op_sel_hi:[0,1,1]
    ds_write_addtid_b32 v54 offset:30688
    ds_write_addtid_b32 v55 offset:48096
    ds_write_addtid_b32 v56 offset:15200
    v_pk_mul_f32 v[58:59], v[28:29], v[22:23] op_sel:[1,0] op_sel_hi:[1,1]
    v_pk_mul_f32 v[60:61], v[32:33], v[22:23] op_sel:[1,0] op_sel_hi:[1,1]
    v_pk_mul_f32 v[62:63], v[38:39], v[26:27] op_sel:[1,0] op_sel_hi:[1,1]
    v_cvt_pk_bf16_f32 v54, v28, v29
    v_cvt_pk_bf16_f32 v55, v32, v33
    v_cvt_pk_bf16_f32 v56, v38, v39
    v_pk_fma_f32 v[30:31], v[28:29], v[20:21], v[58:59] op_sel:[0,0,0] op_sel_hi:[0,1,1]
    v_pk_fma_f32 v[34:35], v[32:33], v[20:21], v[60:61] op_sel:[0,0,0] op_sel_hi:[0,1,1]
    v_pk_fma_f32 v[36:37], v[38:39], v[24:25], v[62:63] op_sel:[0,0,0] op_sel_hi:[0,1,1]
    ds_write_addtid_b32 v54 offset:31232
    ds_write_addtid_b32 v55 offset:48640
    ds_write_addtid_b32 v56 offset:6400
    v_pk_mul_f32 v[58:59], v[30:31], v[22:23] op_sel:[1,0] op_sel_hi:[1,1]
    v_pk_mul_f32 v[60:61], v[34:35], v[22:23] op_sel:[1,0] op_sel_hi:[1,1]
    v_pk_mul_f32 v[62:63], v[42:43], v[26:27] op_sel:[1,0] op_sel_hi:[1,1]
    v_cvt_pk_bf16_f32 v54, v30, v31
    v_cvt_pk_bf16_f32 v55, v34, v35
    v_cvt_pk_bf16_f32 v56, v42, v43
    v_pk_fma_f32 v[28:29], v[30:31], v[20:21], v[58:59] op_sel:[0,0,0] op_sel_hi:[0,1,1]
    v_pk_fma_f32 v[32:33], v[34:35], v[20:21], v[60:61] op_sel:[0,0,0] op_sel_hi:[0,1,1]
    v_pk_fma_f32 v[40:41], v[42:43], v[24:25], v[62:63] op_sel:[0,0,0] op_sel_hi:[0,1,1]
    ds_write_addtid_b32 v54 offset:31776
    ds_write_addtid_b32 v55 offset:49184
    ds_write_addtid_b32 v56 offset:15776
    v_pk_mul_f32 v[58:59], v[28:29], v[22:23] op_sel:[1,0] op_sel_hi:[1,1]
    v_pk_mul_f32 v[60:61], v[32:33], v[22:23] op_sel:[1,0] op_sel_hi:[1,1]
    v_pk_mul_f32 v[62:63], v[36:37], v[26:27] op_sel:[1,0] op_sel_hi:[1,1]
    v_cvt_pk_bf16_f32 v54, v28, v29
    v_cvt_pk_bf16_f32 v55, v32, v33
    v_cvt_pk_bf16_f32 v56, v36, v37
    v_pk_fma_f32 v[30:31], v[28:29], v[20:21], v[58:59] op_sel:[0,0,0] op_sel_hi:[0,1,1]
    v_pk_fma_f32 v[34:35], v[32:33], v[20:21], v[60:61] op_sel:[0,0,0] op_sel_hi:[0,1,1]
    v_pk_fma_f32 v[38:39], v[36:37], v[24:25], v[62:63] op_sel:[0,0,0] op_sel_hi:[0,1,1]
    ds_write_addtid_b32 v54 offset:32320
    ds_write_addtid_b32 v55 offset:49728
    ds_write_addtid_b32 v56 offset:7008
    v_pk_mul_f32 v[58:59], v[30:31], v[22:23] op_sel:[1,0] op_sel_hi:[1,1]
    v_pk_mul_f32 v[60:61], v[34:35], v[22:23] op_sel:[1,0] op_sel_hi:[1,1]
    v_pk_mul_f32 v[62:63], v[40:41], v[26:27] op_sel:[1,0] op_sel_hi:[1,1]
    v_cvt_pk_bf16_f32 v54, v30, v31
    v_cvt_pk_bf16_f32 v55, v34, v35
    v_cvt_pk_bf16_f32 v56, v40, v41
    v_pk_fma_f32 v[28:29], v[30:31], v[20:21], v[58:59] op_sel:[0,0,0] op_sel_hi:[0,1,1]
    v_pk_fma_f32 v[32:33], v[34:35], v[20:21], v[60:61] op_sel:[0,0,0] op_sel_hi:[0,1,1]
    v_pk_fma_f32 v[42:43], v[40:41], v[24:25], v[62:63] op_sel:[0,0,0] op_sel_hi:[0,1,1]
    ds_write_addtid_b32 v54 offset:32864
    ds_write_addtid_b32 v55 offset:50272
    ds_write_addtid_b32 v56 offset:16384
    v_pk_mul_f32 v[58:59], v[28:29], v[22:23] op_sel:[1,0] op_sel_hi:[1,1]
    v_pk_mul_f32 v[60:61], v[32:33], v[22:23] op_sel:[1,0] op_sel_hi:[1,1]
    v_pk_mul_f32 v[62:63], v[38:39], v[26:27] op_sel:[1,0] op_sel_hi:[1,1]
    v_cvt_pk_bf16_f32 v54, v28, v29
    v_cvt_pk_bf16_f32 v55, v32, v33
    v_cvt_pk_bf16_f32 v56, v38, v39
    v_pk_fma_f32 v[30:31], v[28:29], v[20:21], v[58:59] op_sel:[0,0,0] op_sel_hi:[0,1,1]
    v_pk_fma_f32 v[34:35], v[32:33], v[20:21], v[60:61] op_sel:[0,0,0] op_sel_hi:[0,1,1]
    v_pk_fma_f32 v[36:37], v[38:39], v[24:25], v[62:63] op_sel:[0,0,0] op_sel_hi:[0,1,1]
    ds_write_addtid_b32 v54 offset:33408
    ds_write_addtid_b32 v55 offset:50816
    ds_write_addtid_b32 v56 offset:7584
    v_pk_mul_f32 v[58:59], v[30:31], v[22:23] op_sel:[1,0] op_sel_hi:[1,1]
    v_pk_mul_f32 v[60:61], v[34:35], v[22:23] op_sel:[1,0] op_sel_hi:[1,1]
    v_pk_mul_f32 v[62:63], v[42:43], v[26:27] op_sel:[1,0] op_sel_hi:[1,1]
    v_cvt_pk_bf16_f32 v54, v30, v31
    v_cvt_pk_bf16_f32 v55, v34, v35
    v_cvt_pk_bf16_f32 v56, v42, v43
    v_pk_fma_f32 v[28:29], v[30:31], v[20:21], v[58:59] op_sel:[0,0,0] op_sel_hi:[0,1,1]
    v_pk_fma_f32 v[32:33], v[34:35], v[20:21], v[60:61] op_sel:[0,0,0] op_sel_hi:[0,1,1]
    v_pk_fma_f32 v[40:41], v[42:43], v[24:25], v[62:63] op_sel:[0,0,0] op_sel_hi:[0,1,1]
    ds_write_addtid_b32 v54 offset:33952
    ds_write_addtid_b32 v55 offset:51360
    ds_write_addtid_b32 v56 offset:16960
    v_pk_mul_f32 v[58:59], v[28:29], v[22:23] op_sel:[1,0] op_sel_hi:[1,1]
    v_pk_mul_f32 v[60:61], v[32:33], v[22:23] op_sel:[1,0] op_sel_hi:[1,1]
    v_pk_mul_f32 v[62:63], v[36:37], v[26:27] op_sel:[1,0] op_sel_hi:[1,1]
    v_cvt_pk_bf16_f32 v54, v28, v29
    v_cvt_pk_bf16_f32 v55, v32, v33
    v_cvt_pk_bf16_f32 v56, v36, v37
    v_pk_fma_f32 v[30:31], v[28:29], v[20:21], v[58:59] op_sel:[0,0,0] op_sel_hi:[0,1,1]
    v_pk_fma_f32 v[34:35], v[32:33], v[20:21], v[60:61] op_sel:[0,0,0] op_sel_hi:[0,1,1]
    v_pk_fma_f32 v[38:39], v[36:37], v[24:25], v[62:63] op_sel:[0,0,0] op_sel_hi:[0,1,1]
    ds_write_addtid_b32 v54 offset:34496
    ds_write_addtid_b32 v55 offset:51904
    ds_write_addtid_b32 v56 offset:8160
    v_pk_mul_f32 v[58:59], v[30:31], v[22:23] op_sel:[1,0] op_sel_hi:[1,1]
    v_pk_mul_f32 v[60:61], v[34:35], v[22:23] op_sel:[1,0] op_sel_hi:[1,1]
    v_pk_mul_f32 v[62:63], v[40:41], v[26:27] op_sel:[1,0] op_sel_hi:[1,1]
    v_cvt_pk_bf16_f32 v54, v30, v31
    v_cvt_pk_bf16_f32 v55, v34, v35
    v_cvt_pk_bf16_f32 v56, v40, v41
    v_pk_fma_f32 v[28:29], v[30:31], v[20:21], v[58:59] op_sel:[0,0,0] op_sel_hi:[0,1,1]
    v_pk_fma_f32 v[32:33], v[34:35], v[20:21], v[60:61] op_sel:[0,0,0] op_sel_hi:[0,1,1]
    v_pk_fma_f32 v[42:43], v[40:41], v[24:25], v[62:63] op_sel:[0,0,0] op_sel_hi:[0,1,1]
    ds_write_addtid_b32 v54 offset:35040
    ds_write_addtid_b32 v55 offset:52448
    ds_write_addtid_b32 v56 offset:17536
    v_pk_mul_f32 v[58:59], v[28:29], v[22:23] op_sel:[1,0] op_sel_hi:[1,1]
    v_pk_mul_f32 v[60:61], v[32:33], v[22:23] op_sel:[1,0] op_sel_hi:[1,1]
    v_pk_mul_f32 v[62:63], v[38:39], v[26:27] op_sel:[1,0] op_sel_hi:[1,1]
    v_cvt_pk_bf16_f32 v54, v28, v29
    v_cvt_pk_bf16_f32 v55, v32, v33
    v_cvt_pk_bf16_f32 v56, v38, v39
    v_pk_fma_f32 v[30:31], v[28:29], v[20:21], v[58:59] op_sel:[0,0,0] op_sel_hi:[0,1,1]
    v_pk_fma_f32 v[34:35], v[32:33], v[20:21], v[60:61] op_sel:[0,0,0] op_sel_hi:[0,1,1]
    v_pk_fma_f32 v[36:37], v[38:39], v[24:25], v[62:63] op_sel:[0,0,0] op_sel_hi:[0,1,1]
    ds_write_addtid_b32 v54 offset:35584
    ds_write_addtid_b32 v55 offset:52992
    ds_write_addtid_b32 v56 offset:8736
    v_pk_mul_f32 v[58:59], v[30:31], v[22:23] op_sel:[1,0] op_sel_hi:[1,1]
    v_pk_mul_f32 v[60:61], v[34:35], v[22:23] op_sel:[1,0] op_sel_hi:[1,1]
    v_pk_mul_f32 v[62:63], v[42:43], v[26:27] op_sel:[1,0] op_sel_hi:[1,1]
    v_cvt_pk_bf16_f32 v54, v30, v31
    v_cvt_pk_bf16_f32 v55, v34, v35
    v_cvt_pk_bf16_f32 v56, v42, v43
    v_pk_fma_f32 v[28:29], v[30:31], v[20:21], v[58:59] op_sel:[0,0,0] op_sel_hi:[0,1,1]
    v_pk_fma_f32 v[32:33], v[34:35], v[20:21], v[60:61] op_sel:[0,0,0] op_sel_hi:[0,1,1]
    v_pk_fma_f32 v[40:41], v[42:43], v[24:25], v[62:63] op_sel:[0,0,0] op_sel_hi:[0,1,1]
    ds_write_addtid_b32 v54 offset:36128
    ds_write_addtid_b32 v55 offset:53536
    ds_write_addtid_b32 v56 offset:18112
    v_cvt_pk_bf16_f32 v54, v40, v41
    ds_write_addtid_b32 v54 offset:18752
    s_waitcnt vmcnt(1)
    s_lshl_b32 s64, s57, 2
    s_add_u32 s64, s64, 163776
    v_mov_b32 v16, s64
    v_mov_b32 v17, 1
    s_waitcnt lgkmcnt(0)
    s_mov_b64 s[90:91], exec
    s_mov_b64 exec, 1
    ds_add_u32 v16, v17
    s_mov_b64 exec, s[90:91]
    s_mov_b32 s83, 0
L_pair_9:
    ds_read_b32 v17, v16
    s_add_u32 s83, s83, 1
    s_waitcnt lgkmcnt(0)
    v_cmp_gt_u32 vcc, 2, v17
    s_cmp_ge_u32 s83, 240000
    s_cbranch_scc1 L_paird_10
    s_cbranch_vccnz L_pair_9
L_paird_10:
    v_and_b32 v16, 15, v0
    v_lshrrev_b32 v17, 4, v0
    v_mul_u32_u24 v18, 544, v16
    v_lshl_add_u32 v18, v17, 4, v18
    s_add_u32 s64, s63, 19264
    v_add_u32 v18, s64, v18
    s_mul_i32 s64, s57, 16640
    s_add_u32 s64, s64, 119768
    v_lshlrev_b32 v19, 6, v16
    v_lshl_add_u32 v19, v17, 3, v19
    v_sub_u32 v19, s64, v19
    s_and_b32 s60, s3, 1
    s_cmp_eq_u32 s60, 0
    s_cbranch_scc0 L_kpart1_11
    ds_read_b128 v[32:35], v18 offset:0
    ds_read_b128 v[36:39], v18 offset:64
    ds_read_b128 v[40:43], v18 offset:128
    ds_read_b128 v[44:47], v18 offset:192
    ds_read_b128 v[48:51], v18 offset:256
    ds_read_b128 v[52:55], v18 offset:320
    ds_read_b128 v[56:59], v18 offset:384
    ds_read_b128 v[60:63], v18 offset:448
    v_add_u32 v20, 128, v16
    v_add_u32 v21, 144, v16
    v_cvt_f32_u32 v20, v20
    v_cvt_f32_u32 v21, v21
    v_cvt_pk_bf16_f32 v20, v20, v20
    v_cvt_pk_bf16_f32 v21, v21, v21
    v_lshlrev_b32 v20, 16, v20
    v_lshlrev_b32 v21, 16, v21
    v_cvt_u32_f32 v20, v20
    v_cvt_u32_f32 v21, v21
    v_subrev_u32 v20, 128, v20
    v_subrev_u32 v21, 128, v21
    v_lshrrev_b32 v22, 2, v20
    v_lshrrev_b32 v23, 2, v21
    v_lshrrev_b32 v24, 4, v20
    v_lshrrev_b32 v25, 4, v21
    v_mul_u32_u24 v20, 576, v20
    v_mul_u32_u24 v21, 576, v21
    v_add_u32 v22, v22, v24
    v_add_u32 v23, v23, v25
    v_lshl_add_u32 v20, v22, 5, v20
    v_lshl_add_u32 v21, v23, 5, v21
    v_lshl_add_u32 v20, v17, 4, v20
    v_lshl_add_u32 v21, v17, 4, v21
    v_add_u32 v20, s63, v20
    v_add_u32 v21, s63, v21
    ds_read_b128 v[96:99], v20 offset:0
    ds_read_b128 v[128:131], v21 offset:0
    ds_read_b128 v[100:103], v20 offset:64
    ds_read_b128 v[132:135], v21 offset:64
    ds_read_b128 v[104:107], v20 offset:128
    ds_read_b128 v[136:139], v21 offset:128
    ds_read_b128 v[108:111], v20 offset:192
    ds_read_b128 v[140:143], v21 offset:192
    s_waitcnt lgkmcnt(6)
    v_mfma_f32_16x16x32_bf16 v[160:163], v[96:99], v[32:35], 0
    v_mfma_f32_16x16x32_bf16 v[164:167], v[128:131], v[32:35], 0
    ds_read_b128 v[112:115], v20 offset:256
    ds_read_b128 v[144:147], v21 offset:256
    s_waitcnt lgkmcnt(6)
    v_mfma_f32_16x16x32_bf16 v[160:163], v[100:103], v[36:39], v[160:163]
    v_mfma_f32_16x16x32_bf16 v[164:167], v[132:135], v[36:39], v[164:167]
    ds_read_b128 v[116:119], v20 offset:320
    ds_read_b128 v[148:151], v21 offset:320
    s_waitcnt lgkmcnt(6)
    v_mfma_f32_16x16x32_bf16 v[160:163], v[104:107], v[40:43], v[160:163]
    v_mfma_f32_16x16x32_bf16 v[164:167], v[136:139], v[40:43], v[164:167]
    ds_read_b128 v[120:123], v20 offset:384
    ds_read_b128 v[152:155], v21 offset:384
    s_waitcnt lgkmcnt(6)
    v_mfma_f32_16x16x32_bf16 v[160:163], v[108:111], v[44:47], v[160:163]
    v_mfma_f32_16x16x32_bf16 v[164:167], v[140:143], v[44:47], v[164:167]
    ds_read_b128 v[124:127], v20 offset:448
    ds_read_b128 v[156:159], v21 offset:448
    s_waitcnt lgkmcnt(6)
    v_mfma_f32_16x16x32_bf16 v[160:163], v[112:115], v[48:51], v[160:163]
    v_mfma_f32_16x16x32_bf16 v[164:167], v[144:147], v[48:51], v[164:167]
    s_waitcnt lgkmcnt(4)
    v_mfma_f32_16x16x32_bf16 v[160:163], v[116:119], v[52:55], v[160:163]
    v_mfma_f32_16x16x32_bf16 v[164:167], v[148:151], v[52:55], v[164:167]
    s_waitcnt lgkmcnt(2)
    v_mfma_f32_16x16x32_bf16 v[160:163], v[120:123], v[56:59], v[160:163]
    v_mfma_f32_16x16x32_bf16 v[164:167], v[152:155], v[56:59], v[164:167]
    s_waitcnt lgkmcnt(0)
    v_mfma_f32_16x16x32_bf16 v[160:163], v[124:127], v[60:63], v[160:163]
    v_mfma_f32_16x16x32_bf16 v[164:167], v[156:159], v[60:63], v[164:167]
    v_add_u32 v20, 256, v16
    v_add_u32 v21, 272, v16
    v_cvt_f32_u32 v20, v20
    v_cvt_f32_u32 v21, v21
    v_cvt_pk_bf16_f32 v20, v20, v20
    v_cvt_pk_bf16_f32 v21, v21, v21
    v_lshlrev_b32 v20, 16, v20
    v_lshlrev_b32 v21, 16, v21
    v_cvt_u32_f32 v20, v20
    v_cvt_u32_f32 v21, v21
    v_subrev_u32 v20, 256, v20
    v_subrev_u32 v21, 256, v21
    v_lshrrev_b32 v22, 2, v20
    v_lshrrev_b32 v23, 2, v21
    v_lshrrev_b32 v24, 4, v20
    v_lshrrev_b32 v25, 4, v21
    v_mul_u32_u24 v20, 576, v20
    v_mul_u32_u24 v21, 576, v21
    v_add_u32 v22, v22, v24
    v_add_u32 v23, v23, v25
    v_lshl_add_u32 v20, v22, 5, v20
    v_lshl_add_u32 v21, v23, 5, v21
    v_lshl_add_u32 v20, v17, 4, v20
    v_lshl_add_u32 v21, v17, 4, v21
    v_add_u32 v20, s63, v20
    v_add_u32 v21, s63, v21
    ds_read_b128 v[96:99], v20 offset:0
    ds_read_b128 v[128:131], v21 offset:0
    ds_read_b128 v[100:103], v20 offset:64
    ds_read_b128 v[132:135], v21 offset:64
    ds_read_b128 v[104:107], v20 offset:128
    ds_read_b128 v[136:139], v21 offset:128
    ds_read_b128 v[108:111], v20 offset:192
    ds_read_b128 v[140:143], v21 offset:192
    s_waitcnt lgkmcnt(6)
    v_mfma_f32_16x16x32_bf16 v[168:171], v[96:99], v[32:35], 0
    v_mfma_f32_16x16x32_bf16 v[172:175], v[128:131], v[32:35], 0
    ds_read_b128 v[112:115], v20 offset:256
    ds_read_b128 v[144:147], v21 offset:256
    s_waitcnt lgkmcnt(6)
    v_mfma_f32_16x16x32_bf16 v[168:171], v[100:103], v[36:39], v[168:171]
    v_mfma_f32_16x16x32_bf16 v[172:175], v[132:135], v[36:39], v[172:175]
    ds_read_b128 v[116:119], v20 offset:320
    ds_read_b128 v[148:151], v21 offset:320
    s_waitcnt lgkmcnt(6)
    v_mfma_f32_16x16x32_bf16 v[168:171], v[104:107], v[40:43], v[168:171]
    v_mfma_f32_16x16x32_bf16 v[172:175], v[136:139], v[40:43], v[172:175]
    ds_read_b128 v[120:123], v20 offset:384
    ds_read_b128 v[152:155], v21 offset:384
    s_waitcnt lgkmcnt(6)
    v_mfma_f32_16x16x32_bf16 v[168:171], v[108:111], v[44:47], v[168:171]
    v_mfma_f32_16x16x32_bf16 v[172:175], v[140:143], v[44:47], v[172:175]
    ds_read_b128 v[124:127], v20 offset:448
    ds_read_b128 v[156:159], v21 offset:448
    s_waitcnt lgkmcnt(6)
    v_mfma_f32_16x16x32_bf16 v[168:171], v[112:115], v[48:51], v[168:171]
    v_mfma_f32_16x16x32_bf16 v[172:175], v[144:147], v[48:51], v[172:175]
    s_waitcnt lgkmcnt(4)
    v_mfma_f32_16x16x32_bf16 v[168:171], v[116:119], v[52:55], v[168:171]
    v_mfma_f32_16x16x32_bf16 v[172:175], v[148:151], v[52:55], v[172:175]
    s_waitcnt lgkmcnt(2)
    v_mfma_f32_16x16x32_bf16 v[168:171], v[120:123], v[56:59], v[168:171]
    v_mfma_f32_16x16x32_bf16 v[172:175], v[152:155], v[56:59], v[172:175]
    s_waitcnt lgkmcnt(0)
    v_mfma_f32_16x16x32_bf16 v[168:171], v[124:127], v[60:63], v[168:171]
    v_mfma_f32_16x16x32_bf16 v[172:175], v[156:159], v[60:63], v[172:175]
    v_cmp_gt_u32 vcc, 8, v16
    s_nop 5
    v_cndmask_b32 v160, v168, v160, vcc
    v_cndmask_b32 v161, v169, v161, vcc
    v_cndmask_b32 v162, v170, v162, vcc
    v_cndmask_b32 v163, v171, v163, vcc
    v_cndmask_b32 v164, v172, v164, vcc
    v_cndmask_b32 v165, v173, v165, vcc
    v_cndmask_b32 v166, v174, v166, vcc
    v_cndmask_b32 v167, v175, v167, vcc
    v_cvt_pk_bf16_f32 v24, v163, v162
    v_cvt_pk_bf16_f32 v25, v161, v160
    v_cvt_pk_bf16_f32 v26, v167, v166
    v_cvt_pk_bf16_f32 v27, v165, v164
    ds_write_b64 v19, v[24:25] offset:32
    ds_write_b64 v19, v[26:27]
    s_branch L_kparte_12
L_kpart1_11:
    ds_read_b128 v[32:35], v18 offset:8704
    ds_read_b128 v[36:39], v18 offset:8768
    ds_read_b128 v[40:43], v18 offset:8832
    ds_read_b128 v[44:47], v18 offset:8896
    ds_read_b128 v[48:51], v18 offset:8960
    ds_read_b128 v[52:55], v18 offset:9024
    ds_read_b128 v[56:59], v18 offset:9088
    ds_read_b128 v[60:63], v18 offset:9152
    v_add_u32 v20, 512, v16
    v_add_u32 v21, 528, v16
    v_cvt_f32_u32 v20, v20
    v_cvt_f32_u32 v21, v21
    v_cvt_pk_bf16_f32 v20, v20, v20
    v_cvt_pk_bf16_f32 v21, v21, v21
    v_lshlrev_b32 v20, 16, v20
    v_lshlrev_b32 v21, 16, v21
    v_cvt_u32_f32 v20, v20
    v_cvt_u32_f32 v21, v21
    v_subrev_u32 v20, 512, v20
    v_subrev_u32 v21, 512, v21
    v_lshrrev_b32 v22, 2, v20
    v_lshrrev_b32 v23, 2, v21
    v_lshrrev_b32 v24, 4, v20
    v_lshrrev_b32 v25, 4, v21
    v_mul_u32_u24 v20, 576, v20
    v_mul_u32_u24 v21, 576, v21
    v_add_u32 v22, v22, v24
    v_add_u32 v23, v23, v25
    v_lshl_add_u32 v20, v22, 5, v20
    v_lshl_add_u32 v21, v23, 5, v21
    v_lshl_add_u32 v20, v17, 4, v20
    v_lshl_add_u32 v21, v17, 4, v21
    v_add_u32 v20, s63, v20
    v_add_u32 v21, s63, v21
    ds_read_b128 v[96:99], v20 offset:0
    ds_read_b128 v[128:131], v21 offset:0
    ds_read_b128 v[100:103], v20 offset:64
    ds_read_b128 v[132:135], v21 offset:64
    ds_read_b128 v[104:107], v20 offset:128
    ds_read_b128 v[136:139], v21 offset:128
    ds_read_b128 v[108:111], v20 offset:192
    ds_read_b128 v[140:143], v21 offset:192
    s_waitcnt lgkmcnt(6)
    v_mfma_f32_16x16x32_bf16 v[160:163], v[96:99], v[32:35], 0
    v_mfma_f32_16x16x32_bf16 v[164:167], v[128:131], v[32:35], 0
    ds_read_b128 v[112:115], v20 offset:256
    ds_read_b128 v[144:147], v21 offset:256
    s_waitcnt lgkmcnt(6)
    v_mfma_f32_16x16x32_bf16 v[160:163], v[100:103], v[36:39], v[160:163]
    v_mfma_f32_16x16x32_bf16 v[164:167], v[132:135], v[36:39], v[164:167]
    ds_read_b128 v[116:119], v20 offset:320
    ds_read_b128 v[148:151], v21 offset:320
    s_waitcnt lgkmcnt(6)
    v_mfma_f32_16x16x32_bf16 v[160:163], v[104:107], v[40:43], v[160:163]
    v_mfma_f32_16x16x32_bf16 v[164:167], v[136:139], v[40:43], v[164:167]
    ds_read_b128 v[120:123], v20 offset:384
    ds_read_b128 v[152:155], v21 offset:384
    s_waitcnt lgkmcnt(6)
    v_mfma_f32_16x16x32_bf16 v[160:163], v[108:111], v[44:47], v[160:163]
    v_mfma_f32_16x16x32_bf16 v[164:167], v[140:143], v[44:47], v[164:167]
    ds_read_b128 v[124:127], v20 offset:448
    ds_read_b128 v[156:159], v21 offset:448
    s_waitcnt lgkmcnt(6)
    v_mfma_f32_16x16x32_bf16 v[160:163], v[112:115], v[48:51], v[160:163]
    v_mfma_f32_16x16x32_bf16 v[164:167], v[144:147], v[48:51], v[164:167]
    s_waitcnt lgkmcnt(4)
    v_mfma_f32_16x16x32_bf16 v[160:163], v[116:119], v[52:55], v[160:163]
    v_mfma_f32_16x16x32_bf16 v[164:167], v[148:151], v[52:55], v[164:167]
    s_waitcnt lgkmcnt(2)
    v_mfma_f32_16x16x32_bf16 v[160:163], v[120:123], v[56:59], v[160:163]
    v_mfma_f32_16x16x32_bf16 v[164:167], v[152:155], v[56:59], v[164:167]
    s_waitcnt lgkmcnt(0)
    v_mfma_f32_16x16x32_bf16 v[160:163], v[124:127], v[60:63], v[160:163]
    v_mfma_f32_16x16x32_bf16 v[164:167], v[156:159], v[60:63], v[164:167]
    ds_read_b128 v[32:35], v18 offset:17408
    ds_read_b128 v[36:39], v18 offset:17472
    ds_read_b128 v[40:43], v18 offset:17536
    ds_read_b128 v[44:47], v18 offset:17600
    ds_read_b128 v[48:51], v18 offset:17664
    ds_read_b128 v[52:55], v18 offset:17728
    ds_read_b128 v[56:59], v18 offset:17792
    ds_read_b128 v[60:63], v18 offset:17856
    ds_read_b128 v[64:67], v18 offset:26112
    ds_read_b128 v[68:71], v18 offset:26176
    ds_read_b128 v[72:75], v18 offset:26240
    ds_read_b128 v[76:79], v18 offset:26304
    ds_read_b128 v[80:83], v18 offset:26368
    ds_read_b128 v[84:87], v18 offset:26432
    ds_read_b128 v[88:91], v18 offset:26496
    ds_read_b128 v[92:95], v18 offset:26560
    v_add_u32 v20, 1024, v16
    v_add_u32 v21, 1040, v16
    v_cvt_f32_u32 v20, v20
    v_cvt_f32_u32 v21, v21
    v_cvt_pk_bf16_f32 v20, v20, v20
    v_cvt_pk_bf16_f32 v21, v21, v21
    v_lshlrev_b32 v20, 16, v20
    v_lshlrev_b32 v21, 16, v21
    v_cvt_u32_f32 v20, v20
    v_cvt_u32_f32 v21, v21
    v_subrev_u32 v20, 1024, v20
    v_subrev_u32 v21, 1024, v21
    v_lshrrev_b32 v22, 2, v20
    v_lshrrev_b32 v23, 2, v21
    v_lshrrev_b32 v24, 4, v20
    v_lshrrev_b32 v25, 4, v21
    v_mul_u32_u24 v20, 576, v20
    v_mul_u32_u24 v21, 576, v21
    v_add_u32 v22, v22, v24
    v_add_u32 v23, v23, v25
    v_lshl_add_u32 v20, v22, 5, v20
    v_lshl_add_u32 v21, v23, 5, v21
    v_lshl_add_u32 v20, v17, 4, v20
    v_lshl_add_u32 v21, v17, 4, v21
    v_add_u32 v20, s63, v20
    v_add_u32 v21, s63, v21
    v_cvt_pk_bf16_f32 v24, v163, v162
    v_cvt_pk_bf16_f32 v25, v161, v160
    v_cvt_pk_bf16_f32 v26, v167, v166
    v_cvt_pk_bf16_f32 v27, v165, v164
    v_subrev_u32 v28, 1024, v19
    ds_write_b64 v28, v[24:25] offset:32
    ds_write_b64 v28, v[26:27]
    ds_read_b128 v[96:99], v20 offset:0
    ds_read_b128 v[128:131], v21 offset:0
    ds_read_b128 v[100:103], v20 offset:64
    ds_read_b128 v[132:135], v21 offset:64
    ds_read_b128 v[104:107], v20 offset:128
    ds_read_b128 v[136:139], v21 offset:128
    ds_read_b128 v[108:111], v20 offset:192
    ds_read_b128 v[140:143], v21 offset:192
    s_waitcnt lgkmcnt(6)
    v_mfma_f32_16x16x32_bf16 v[168:171], v[96:99], v[32:35], 0
    v_mfma_f32_16x16x32_bf16 v[172:175], v[128:131], v[32:35], 0
    v_mfma_f32_16x16x32_bf16 v[176:179], v[96:99], v[64:67], 0
    v_mfma_f32_16x16x32_bf16 v[180:183], v[128:131], v[64:67], 0
    ds_read_b128 v[112:115], v20 offset:256
    ds_read_b128 v[144:147], v21 offset:256
    s_waitcnt lgkmcnt(6)
    v_mfma_f32_16x16x32_bf16 v[168:171], v[100:103], v[36:39], v[168:171]
    v_mfma_f32_16x16x32_bf16 v[172:175], v[132:135], v[36:39], v[172:175]
    v_mfma_f32_16x16x32_bf16 v[176:179], v[100:103], v[68:71], v[176:179]
    v_mfma_f32_16x16x32_bf16 v[180:183], v[132:135], v[68:71], v[180:183]
    ds_read_b128 v[116:119], v20 offset:320
    ds_read_b128 v[148:151], v21 offset:320
    s_waitcnt lgkmcnt(6)
    v_mfma_f32_16x16x32_bf16 v[168:171], v[104:107], v[40:43], v[168:171]
    v_mfma_f32_16x16x32_bf16 v[172:175], v[136:139], v[40:43], v[172:175]
    v_mfma_f32_16x16x32_bf16 v[176:179], v[104:107], v[72:75], v[176:179]
    v_mfma_f32_16x16x32_bf16 v[180:183], v[136:139], v[72:75], v[180:183]
    ds_read_b128 v[120:123], v20 offset:384
    ds_read_b128 v[152:155], v21 offset:384
    s_waitcnt lgkmcnt(6)
    v_mfma_f32_16x16x32_bf16 v[168:171], v[108:111], v[44:47], v[168:171]
    v_mfma_f32_16x16x32_bf16 v[172:175], v[140:143], v[44:47], v[172:175]
    v_mfma_f32_16x16x32_bf16 v[176:179], v[108:111], v[76:79], v[176:179]
    v_mfma_f32_16x16x32_bf16 v[180:183], v[140:143], v[76:79], v[180:183]
    ds_read_b128 v[124:127], v20 offset:448
    ds_read_b128 v[156:159], v21 offset:448
    s_waitcnt lgkmcnt(6)
    v_mfma_f32_16x16x32_bf16 v[168:171], v[112:115], v[48:51], v[168:171]
    v_mfma_f32_16x16x32_bf16 v[172:175], v[144:147], v[48:51], v[172:175]
    v_mfma_f32_16x16x32_bf16 v[176:179], v[112:115], v[80:83], v[176:179]
    v_mfma_f32_16x16x32_bf16 v[180:183], v[144:147], v[80:83], v[180:183]
    s_waitcnt lgkmcnt(4)
    v_mfma_f32_16x16x32_bf16 v[168:171], v[116:119], v[52:55], v[168:171]
    v_mfma_f32_16x16x32_bf16 v[172:175], v[148:151], v[52:55], v[172:175]
    v_mfma_f32_16x16x32_bf16 v[176:179], v[116:119], v[84:87], v[176:179]
    v_mfma_f32_16x16x32_bf16 v[180:183], v[148:151], v[84:87], v[180:183]
    s_waitcnt lgkmcnt(2)
    v_mfma_f32_16x16x32_bf16 v[168:171], v[120:123], v[56:59], v[168:171]
    v_mfma_f32_16x16x32_bf16 v[172:175], v[152:155], v[56:59], v[172:175]
    v_mfma_f32_16x16x32_bf16 v[176:179], v[120:123], v[88:91], v[176:179]
    v_mfma_f32_16x16x32_bf16 v[180:183], v[152:155], v[88:91], v[180:183]
    s_waitcnt lgkmcnt(0)
    v_mfma_f32_16x16x32_bf16 v[168:171], v[124:127], v[60:63], v[168:171]
    v_mfma_f32_16x16x32_bf16 v[172:175], v[156:159], v[60:63], v[172:175]
    v_mfma_f32_16x16x32_bf16 v[176:179], v[124:127], v[92:95], v[176:179]
    v_mfma_f32_16x16x32_bf16 v[180:183], v[156:159], v[92:95], v[180:183]
    s_nop 4
    v_cvt_pk_bf16_f32 v24, v171, v170
    v_cvt_pk_bf16_f32 v25, v169, v168
    v_cvt_pk_bf16_f32 v26, v175, v174
    v_cvt_pk_bf16_f32 v27, v173, v172
    v_subrev_u32 v28, 2048, v19
    ds_write_b64 v28, v[24:25] offset:32
    ds_write_b64 v28, v[26:27]
    v_cvt_pk_bf16_f32 v24, v179, v178
    v_cvt_pk_bf16_f32 v25, v177, v176
    v_cvt_pk_bf16_f32 v26, v183, v182
    v_cvt_pk_bf16_f32 v27, v181, v180
    v_subrev_u32 v28, 3072, v19
    ds_write_b64 v28, v[24:25] offset:32
    ds_write_b64 v28, v[26:27]
L_kparte_12:
    s_mul_i32 s64, s57, 16640
    s_mul_i32 s66, s60, 8320
    s_add_u32 s64, s64, s66
    s_add_u32 s64, s64, 119808
    v_lshl_add_u32 v28, v16, 2, s64
    v_mov_b32 v29, 0
    ds_write_b32 v28, v29
    ds_write_b32 v28, v29 offset:4160
    v_mov_b32 v16, 163804
    s_lshl_b32 s64, s57, 2
    s_add_u32 s64, s64, 163776
    v_mov_b32 v18, s64
    v_mov_b32 v17, 1
    s_waitcnt lgkmcnt(0)
    s_mov_b64 s[90:91], exec
    s_mov_b64 exec, 1
    ds_add_u32 v16, v17
    ds_add_u32 v18, v17
    s_mov_b64 exec, s[90:91]
    s_mov_b32 s83, 0
L_krpair_13:
    ds_read_b32 v17, v18
    s_add_u32 s83, s83, 1
    s_waitcnt lgkmcnt(0)
    v_cmp_gt_u32 vcc, 4, v17
    s_cmp_ge_u32 s83, 1920000
    s_cbranch_scc1 L_krpaird_14
    s_cbranch_vccz L_krpaird_14
    s_branch L_krpair_13
L_krpaird_14:
    s_mul_i32 s64, s57, 16640
    s_add_u32 s64, s64, 115712
    s_and_b32 s66, s3, 1
    s_lshl_b32 s66, s66, 10
    s_add_u32 s64, s64, s66
    v_lshl_add_u32 v16, v0, 4, s64
    ds_read_b128 v[20:23], v16 offset:0
    ds_read_b64 v[24:25], v16 offset:16
    ds_read_b128 v[28:31], v16 offset:2048
    ds_read_b64 v[32:33], v16 offset:2064
    s_waitcnt lgkmcnt(2)
    v_alignbit_b32 v36, v21, v20, 16
    v_mov_b32 v40, v21
    v_alignbit_b32 v44, v22, v21, 16
    v_alignbit_b32 v37, v22, v21, 16
    v_mov_b32 v41, v22
    v_alignbit_b32 v45, v23, v22, 16
    v_alignbit_b32 v38, v23, v22, 16
    v_mov_b32 v42, v23
    v_alignbit_b32 v46, v24, v23, 16
    v_alignbit_b32 v39, v24, v23, 16
    v_mov_b32 v43, v24
    v_alignbit_b32 v47, v25, v24, 16
    ds_write_b128 v16, v[36:39] offset:4160
    ds_write_b128 v16, v[40:43] offset:8320
    ds_write_b128 v16, v[44:47] offset:12480
    s_waitcnt lgkmcnt(3)
    v_alignbit_b32 v48, v29, v28, 16
    v_mov_b32 v52, v29
    v_alignbit_b32 v56, v30, v29, 16
    v_alignbit_b32 v49, v30, v29, 16
    v_mov_b32 v53, v30
    v_alignbit_b32 v57, v31, v30, 16
    v_alignbit_b32 v50, v31, v30, 16
    v_mov_b32 v54, v31
    v_alignbit_b32 v58, v32, v31, 16
    v_alignbit_b32 v51, v32, v31, 16
    v_mov_b32 v55, v32
    v_alignbit_b32 v59, v33, v32, 16
    ds_write_b128 v16, v[48:51] offset:6208
    ds_write_b128 v16, v[52:55] offset:10368
    ds_write_b128 v16, v[56:59] offset:14528
    s_branch L_S2_2
L_Upath_1:
    s_setprio 1
    s_sub_u32 s70, s3, 4
    s_mov_b32 s8, s20
    s_mov_b32 s9, s21
    s_mov_b32 s10, 2097152
    s_mov_b32 s11, 0x20000
    s_barrier
    s_cmp_eq_u32 s70, 0
    s_cbranch_scc0 L_nowarm_15
    v_lshlrev_b32 v30, 10, v0
    s_lshl_b32 s62, s49, 16
    s_lshl_b32 s63, s48, 7
    s_add_u32 s62, s62, s63
    buffer_load_dword v31, v30, s[8:11], s62 offen
L_nowarm_15:
    s_cmp_eq_u32 s70, 1
    s_cbranch_scc0 L_nocode_16
    s_getpc_b64 s[16:17]
L_pcref:
    s_sub_u32 s16, s16, L_pcref-sequential_preLN__ssm_conv_s4d__geglu_ffn__prompt_kernel
    s_subb_u32 s17, s17, 0
    s_mov_b32 s18, L_end-sequential_preLN__ssm_conv_s4d__geglu_ffn__prompt_kernel
    s_mov_b32 s19, 0x20000
    s_and_b32 s63, s49, 3
    s_mul_i32 s63, s63, 9216
    v_lshlrev_b32 v30, 7, v0
    buffer_load_dword v31, v30, s[16:19], s63 offen
    s_add_u32 s63, s63, 8192
    buffer_load_dword v31, v30, s[16:19], s63 offen
L_nocode_16:
    s_cmp_eq_u32 s70, 3
    s_cbranch_scc0 L_notouch0_17
    v_mov_b32 v30, 0
    s_lshl_b32 s63, s2, 6
    s_add_u32 s63, s63, 16384
    buffer_load_dword v31, v30, s[4:7], s63 offen sc1
L_notouch0_17:
    v_lshlrev_b32 v6, 12, v0
    s_lshl_b32 s68, s70, 1
    s_add_u32 s68, s68, s49
    s_and_b32 s68, s68, 7
    s_lshl_b32 s69, s70, 1
    s_add_u32 s69, s69, s49
    s_add_u32 s69, s69, 1
    s_and_b32 s69, s69, 7
    s_lshl_b32 s63, s68, 18
    s_lshl_b32 s65, s50, 2
    s_add_u32 s63, s63, s65
    s_lshl_b32 s64, s69, 18
    s_lshl_b32 s65, s50, 2
    s_add_u32 s64, s64, s65
    s_lshl_b32 s66, s68, 11
    s_add_u32 s66, s66, 16384
    s_lshl_b32 s67, s69, 11
    s_add_u32 s67, s67, 16384
    v_lshlrev_b32 v9, 5, v0
    s_waitcnt lgkmcnt(0)
    s_mul_i32 s84, s84, 1664525
    s_add_u32 s84, s84, 1013904223
    v_mov_b32 v22, 163788
    s_mov_b32 s83, 0
L_pubwait_18:
    ds_read_b32 v23, v22
    s_add_u32 s83, s83, 1
    s_waitcnt lgkmcnt(0)
    v_cmp_gt_u32 vcc, 4, v23
    s_cmp_ge_u32 s83, 1920000
    s_cbranch_scc1 L_pubwaitd_19
    s_cbranch_vccz L_pubwaitd_19
    s_sleep 1
    s_branch L_pubwait_18
L_pubwaitd_19:
    buffer_load_dword v12, v6, s[8:11], s63 offen offset:0
    buffer_load_dword v13, v6, s[8:11], s63 offen offset:1024
    buffer_load_dword v14, v6, s[8:11], s63 offen offset:2048
    buffer_load_dword v15, v6, s[8:11], s63 offen offset:3072
    buffer_load_dword v16, v6, s[8:11], s64 offen offset:0
    buffer_load_dword v17, v6, s[8:11], s64 offen offset:1024
    buffer_load_dword v18, v6, s[8:11], s64 offen offset:2048
    buffer_load_dword v19, v6, s[8:11], s64 offen offset:3072
    buffer_load_dwordx4 v[20:23], v9, s[4:7], s66 offen
    buffer_load_dwordx4 v[24:27], v9, s[4:7], s66 offen offset:16
    buffer_load_dwordx4 v[28:31], v9, s[4:7], s67 offen
    buffer_load_dwordx4 v[32:35], v9, s[4:7], s67 offen offset:16
    s_waitcnt vmcnt(4)
    s_mov_b32 s59, 0x05040100
    s_mov_b32 s60, 0x07060302
    v_perm_b32 v72, v13, v12, s59
    v_perm_b32 v73, v15, v14, s59
    v_perm_b32 v74, v13, v12, s60
    v_perm_b32 v75, v15, v14, s60
    v_perm_b32 v80, v17, v16, s59
    v_perm_b32 v81, v19, v18, s59
    v_perm_b32 v82, v17, v16, s60
    v_perm_b32 v83, v19, v18, s60
    s_mov_b32 s83, 0
L_gchk_20:
    s_waitcnt vmcnt(0)
    v_xor_b32 v36, s84, v21
    v_xor_b32 v37, s84, v23
    v_xor_b32 v38, s84, v25
    v_xor_b32 v39, s84, v27
    v_xor_b32 v40, s84, v29
    v_xor_b32 v41, s84, v31
    v_xor_b32 v42, s84, v33
    v_xor_b32 v43, s84, v35
    v_or3_b32 v36, v36, v37, v38
    v_or3_b32 v39, v39, v40, v41
    v_or3_b32 v42, v42, v43, v36
    v_or_b32 v36, v39, v42
    v_cmp_ne_u32 vcc, 0, v36
    s_add_u32 s83, s83, 1
    s_cmp_ge_u32 s83, 30000
    s_cbranch_scc1 L_gok_21
    s_cbranch_vccz L_gok_21
    buffer_load_dwordx4 v[20:23], v9, s[4:7], s66 offen sc1
    buffer_load_dwordx4 v[24:27], v9, s[4:7], s66 offen offset:16 sc1
    buffer_load_dwordx4 v[28:31], v9, s[4:7], s67 offen sc1
    buffer_load_dwordx4 v[32:35], v9, s[4:7], s67 offen offset:16 sc1
    s_branch L_gchk_20
L_gok_21:
    v_and_b32 v40, 0xffff0000, v20
    v_lshlrev_b32 v36, 16, v20
    v_rcp_f32 v40, v40
    v_and_b32 v41, 0xffff0000, v22
    v_lshlrev_b32 v37, 16, v22
    v_rcp_f32 v41, v41
    v_and_b32 v42, 0xffff0000, v24
    v_lshlrev_b32 v38, 16, v24
    v_rcp_f32 v42, v42
    v_and_b32 v43, 0xffff0000, v26
    v_lshlrev_b32 v39, 16, v26
    v_rcp_f32 v43, v43
    v_lshlrev_b32 v52, 16, v12
    v_and_b32 v60, 0xffff0000, v12
    v_lshlrev_b32 v53, 16, v13
    v_and_b32 v61, 0xffff0000, v13
    v_lshlrev_b32 v54, 16, v14
    v_and_b32 v62, 0xffff0000, v14
    v_lshlrev_b32 v55, 16, v15
    v_and_b32 v63, 0xffff0000, v15
    v_sub_f32 v52, v52, v36
    v_sub_f32 v60, v60, v36
    v_sub_f32 v53, v53, v37
    v_sub_f32 v61, v61, v37
    v_sub_f32 v54, v54, v38
    v_sub_f32 v62, v62, v38
    v_sub_f32 v55, v55, v39
    v_sub_f32 v63, v63, v39
    v_cvt_pk_bf16_f32 v56, v52, v53
    v_cvt_pk_bf16_f32 v57, v54, v55
    v_cvt_pk_bf16_f32 v64, v60, v61
    v_cvt_pk_bf16_f32 v65, v62, v63
    v_lshlrev_b32 v52, 16, v56
    v_and_b32 v53, 0xffff0000, v56
    v_lshlrev_b32 v54, 16, v57
    v_and_b32 v55, 0xffff0000, v57
    v_lshlrev_b32 v60, 16, v64
    v_and_b32 v61, 0xffff0000, v64
    v_lshlrev_b32 v62, 16, v65
    v_and_b32 v63, 0xffff0000, v65
    v_mul_f32 v52, v52, v40
    v_mul_f32 v60, v60, v40
    v_mul_f32 v53, v53, v41
    v_mul_f32 v61, v61, v41
    v_mul_f32 v54, v54, v42
    v_mul_f32 v62, v62, v42
    v_mul_f32 v55, v55, v43
    v_mul_f32 v63, v63, v43
    v_cvt_pk_bf16_f32 v68, v52, v53
    v_cvt_pk_bf16_f32 v69, v54, v55
    v_cvt_pk_bf16_f32 v70, v60, v61
    v_cvt_pk_bf16_f32 v71, v62, v63
    v_and_b32 v40, 0xffff0000, v28
    v_lshlrev_b32 v36, 16, v28
    v_rcp_f32 v40, v40
    v_and_b32 v41, 0xffff0000, v30
    v_lshlrev_b32 v37, 16, v30
    v_rcp_f32 v41, v41
    v_and_b32 v42, 0xffff0000, v32
    v_lshlrev_b32 v38, 16, v32
    v_rcp_f32 v42, v42
    v_and_b32 v43, 0xffff0000, v34
    v_lshlrev_b32 v39, 16, v34
    v_rcp_f32 v43, v43
    v_lshlrev_b32 v52, 16, v16
    v_and_b32 v60, 0xffff0000, v16
    v_lshlrev_b32 v53, 16, v17
    v_and_b32 v61, 0xffff0000, v17
    v_lshlrev_b32 v54, 16, v18
    v_and_b32 v62, 0xffff0000, v18
    v_lshlrev_b32 v55, 16, v19
    v_and_b32 v63, 0xffff0000, v19
    v_sub_f32 v52, v52, v36
    v_sub_f32 v60, v60, v36
    v_sub_f32 v53, v53, v37
    v_sub_f32 v61, v61, v37
    v_sub_f32 v54, v54, v38
    v_sub_f32 v62, v62, v38
    v_sub_f32 v55, v55, v39
    v_sub_f32 v63, v63, v39
    v_cvt_pk_bf16_f32 v56, v52, v53
    v_cvt_pk_bf16_f32 v57, v54, v55
    v_cvt_pk_bf16_f32 v64, v60, v61
    v_cvt_pk_bf16_f32 v65, v62, v63
    v_lshlrev_b32 v52, 16, v56
    v_and_b32 v53, 0xffff0000, v56
    v_lshlrev_b32 v54, 16, v57
    v_and_b32 v55, 0xffff0000, v57
    v_lshlrev_b32 v60, 16, v64
    v_and_b32 v61, 0xffff0000, v64
    v_lshlrev_b32 v62, 16, v65
    v_and_b32 v63, 0xffff0000, v65
    v_mul_f32 v52, v52, v40
    v_mul_f32 v60, v60, v40
    v_mul_f32 v53, v53, v41
    v_mul_f32 v61, v61, v41
    v_mul_f32 v54, v54, v42
    v_mul_f32 v62, v62, v42
    v_mul_f32 v55, v55, v43
    v_mul_f32 v63, v63, v43
    v_cvt_pk_bf16_f32 v76, v52, v53
    v_cvt_pk_bf16_f32 v77, v54, v55
    v_cvt_pk_bf16_f32 v78, v60, v61
    v_cvt_pk_bf16_f32 v79, v62, v63
    v_mov_b32 v22, 163804
    s_mov_b32 s83, 0
L_c2wait_22:
    ds_read_b32 v23, v22
    s_add_u32 s83, s83, 1
    s_waitcnt lgkmcnt(0)
    v_cmp_gt_u32 vcc, 4, v23
    s_cmp_ge_u32 s83, 1920000
    s_cbranch_scc1 L_c2waitd_23
    s_cbranch_vccz L_c2waitd_23
    s_branch L_c2wait_22
L_c2waitd_23:
    s_lshl_b32 s61, s68, 9
    v_lshl_add_u32 v9, v0, 3, s61
    ds_write_b64 v9, v[68:69] offset:512
    ds_write_b64 v9, v[70:71] offset:5120
    ds_write_b64 v9, v[72:73] offset:41984
    ds_write_b64 v9, v[74:75] offset:46080
    s_lshl_b32 s61, s69, 9
    v_lshl_add_u32 v9, v0, 3, s61
    ds_write_b64 v9, v[76:77] offset:512
    ds_write_b64 v9, v[78:79] offset:5120
    ds_write_b64 v9, v[80:81] offset:41984
    ds_write_b64 v9, v[82:83] offset:46080
    s_and_b32 s62, s3, 1
    s_mul_i32 s62, s62, 4608
    v_lshl_add_u32 v10, v0, 3, s62
    v_mov_b32 v4, 0
    v_mov_b32 v5, 0
    ds_write_b64 v10, v[4:5] offset:0
    s_setprio 0
L_S2_2:
    s_waitcnt lgkmcnt(0)
    s_barrier
    s_cmp_ge_u32 s3, 4
    s_cbranch_scc1 L_noconv_24
    s_lshr_b32 s57, s3, 1
    s_and_b32 s58, s3, 1
    v_and_b32 v164, 15, v0
    v_lshrrev_b32 v165, 4, v0
    s_lshl_b32 s60, s58, 8
    v_lshlrev_b32 v166, 5, v164
    v_lshl_add_u32 v166, v165, 4, v166
    s_mul_i32 s59, s57, 4608
    s_sub_u32 s59, s59, s60
    s_add_u32 s59, s59, 288
    v_add_u32 v3, s59, v166
    v_and_b32 v166, 3, v164
    v_sub_u32 v166, 3, v166
    v_mul_u32_u24 v166, 4160, v166
    v_lshrrev_b32 v167, 2, v164
    v_lshlrev_b32 v167, 3, v167
    v_sub_u32 v166, v166, v167
    v_lshl_add_u32 v166, v165, 4, v166
    s_mul_i32 s59, s57, 16640
    s_sub_u32 s59, s59, s60
    s_add_u32 s59, s59, 115992
    v_add_u32 v2, s59, v166
    ds_read_b128 v[68:71], v3 offset:192
    ds_read_b64 v[36:37], v2 offset:3776
    ds_read_b64 v[38:39], v2 offset:3784
    ds_read_b128 v[72:75], v3 offset:704
    ds_read_b64 v[40:41], v2 offset:3264
    ds_read_b64 v[42:43], v2 offset:3272
    ds_read_b128 v[76:79], v3 offset:1216
    ds_read_b64 v[44:45], v2 offset:2752
    ds_read_b64 v[46:47], v2 offset:2760
    ds_read_b128 v[80:83], v3 offset:1728
    ds_read_b64 v[48:49], v2 offset:2240
    ds_read_b64 v[50:51], v2 offset:2248
    ds_read_b128 v[84:87], v3 offset:2240
    ds_read_b64 v[52:53], v2 offset:1728
    ds_read_b64 v[54:55], v2 offset:1736
    s_waitcnt lgkmcnt(12)
    v_mfma_f32_16x16x32_bf16 v[4:7], v[36:39], v[68:71], 0
    ds_read_b128 v[88:91], v3 offset:2752
    s_waitcnt lgkmcnt(10)
    v_mfma_f32_16x16x32_bf16 v[8:11], v[36:39], v[72:75], 0
    ds_read_b64 v[56:57], v2 offset:1216
    v_mfma_f32_16x16x32_bf16 v[8:11], v[40:43], v[68:71], v[8:11]
    ds_read_b64 v[58:59], v2 offset:1224
    v_mfma_f32_16x16x32_bf16 v[12:15], v[40:43], v[72:75], 0
    ds_read_b128 v[92:95], v3 offset:3264
    s_waitcnt lgkmcnt(10)
    v_mfma_f32_16x16x32_bf16 v[12:15], v[36:39], v[76:79], v[12:15]
    ds_read_b64 v[60:61], v2 offset:704
    v_mfma_f32_16x16x32_bf16 v[12:15], v[44:47], v[68:71], v[12:15]
    ds_read_b64 v[62:63], v2 offset:712
    v_mfma_f32_16x16x32_bf16 v[16:19], v[40:43], v[76:79], 0
    ds_read_b128 v[96:99], v3 offset:3776
    v_mfma_f32_16x16x32_bf16 v[16:19], v[44:47], v[72:75], v[16:19]
    ds_read_b64 v[64:65], v2 offset:192
    v_mfma_f32_16x16x32_bf16 v[20:23], v[44:47], v[76:79], 0
    ds_read_b64 v[66:67], v2 offset:200
    s_waitcnt lgkmcnt(12)
    v_mfma_f32_16x16x32_bf16 v[16:19], v[36:39], v[80:83], v[16:19]
    ds_read_b128 v[132:135], v3 offset:128
    v_mfma_f32_16x16x32_bf16 v[16:19], v[48:51], v[68:71], v[16:19]
    ds_read_b64 v[100:101], v2 offset:3712
    v_mfma_f32_16x16x32_bf16 v[20:23], v[40:43], v[80:83], v[20:23]
    ds_read_b64 v[102:103], v2 offset:3720
    v_mfma_f32_16x16x32_bf16 v[20:23], v[48:51], v[72:75], v[20:23]
    v_mfma_f32_16x16x32_bf16 v[24:27], v[44:47], v[80:83], 0
    v_mfma_f32_16x16x32_bf16 v[24:27], v[48:51], v[76:79], v[24:27]
    v_mfma_f32_16x16x32_bf16 v[28:31], v[48:51], v[80:83], 0
    s_waitcnt lgkmcnt(12)
    v_mfma_f32_16x16x32_bf16 v[20:23], v[36:39], v[84:87], v[20:23]
    ds_read_b128 v[136:139], v3 offset:640
    v_mfma_f32_16x16x32_bf16 v[20:23], v[52:55], v[68:71], v[20:23]
    ds_read_b64 v[104:105], v2 offset:3200
    v_mfma_f32_16x16x32_bf16 v[24:27], v[40:43], v[84:87], v[24:27]
    ds_read_b64 v[106:107], v2 offset:3208
    v_mfma_f32_16x16x32_bf16 v[24:27], v[52:55], v[72:75], v[24:27]
    v_mfma_f32_16x16x32_bf16 v[28:31], v[44:47], v[84:87], v[28:31]
    v_mfma_f32_16x16x32_bf16 v[28:31], v[52:55], v[76:79], v[28:31]
    v_mfma_f32_16x16x32_bf16 v[32:35], v[48:51], v[84:87], 0
    v_mfma_f32_16x16x32_bf16 v[32:35], v[52:55], v[80:83], v[32:35]
    s_waitcnt lgkmcnt(12)
    v_mfma_f32_16x16x32_bf16 v[24:27], v[36:39], v[88:91], v[24:27]
    ds_read_b128 v[140:143], v3 offset:1152
    v_mfma_f32_16x16x32_bf16 v[24:27], v[56:59], v[68:71], v[24:27]
    ds_read_b64 v[108:109], v2 offset:2688
    v_mfma_f32_16x16x32_bf16 v[28:31], v[40:43], v[88:91], v[28:31]
    ds_read_b64 v[110:111], v2 offset:2696
    v_mfma_f32_16x16x32_bf16 v[28:31], v[56:59], v[72:75], v[28:31]
    v_mfma_f32_16x16x32_bf16 v[32:35], v[44:47], v[88:91], v[32:35]
    v_mfma_f32_16x16x32_bf16 v[32:35], v[56:59], v[76:79], v[32:35]
    s_waitcnt lgkmcnt(12)
    v_mfma_f32_16x16x32_bf16 v[28:31], v[36:39], v[92:95], v[28:31]
    ds_read_b128 v[144:147], v3 offset:1664
    v_mfma_f32_16x16x32_bf16 v[28:31], v[60:63], v[68:71], v[28:31]
    ds_read_b64 v[112:113], v2 offset:2176
    v_mfma_f32_16x16x32_bf16 v[32:35], v[40:43], v[92:95], v[32:35]
    ds_read_b64 v[114:115], v2 offset:2184
    v_mfma_f32_16x16x32_bf16 v[32:35], v[60:63], v[72:75], v[32:35]
    s_waitcnt lgkmcnt(12)
    v_mfma_f32_16x16x32_bf16 v[32:35], v[36:39], v[96:99], v[32:35]
    ds_read_b128 v[148:151], v3 offset:2176
    v_mfma_f32_16x16x32_bf16 v[32:35], v[64:67], v[68:71], v[32:35]
    ds_read_b64 v[116:117], v2 offset:1664
    s_waitcnt lgkmcnt(11)
    v_mfma_f32_16x16x32_bf16 v[4:7], v[100:103], v[132:135], v[4:7]
    ds_read_b64 v[118:119], v2 offset:1672
    s_waitcnt lgkmcnt(9)
    v_mfma_f32_16x16x32_bf16 v[8:11], v[100:103], v[136:139], v[8:11]
    ds_read_b128 v[152:155], v3 offset:2688
    v_mfma_f32_16x16x32_bf16 v[8:11], v[104:107], v[132:135], v[8:11]
    ds_read_b64 v[120:121], v2 offset:1152
    v_mfma_f32_16x16x32_bf16 v[12:15], v[104:107], v[136:139], v[12:15]
    ds_read_b64 v[122:123], v2 offset:1160
    s_waitcnt lgkmcnt(9)
    v_mfma_f32_16x16x32_bf16 v[12:15], v[100:103], v[140:143], v[12:15]
    ds_read_b128 v[156:159], v3 offset:3200
    v_mfma_f32_16x16x32_bf16 v[12:15], v[108:111], v[132:135], v[12:15]
    ds_read_b64 v[124:125], v2 offset:640
    v_mfma_f32_16x16x32_bf16 v[16:19], v[104:107], v[140:143], v[16:19]
    ds_read_b64 v[126:127], v2 offset:648
    v_mfma_f32_16x16x32_bf16 v[16:19], v[108:111], v[136:139], v[16:19]
    ds_read_b128 v[160:163], v3 offset:3712
    v_mfma_f32_16x16x32_bf16 v[20:23], v[108:111], v[140:143], v[20:23]
    ds_read_b64 v[128:129], v2 offset:128
    s_waitcnt lgkmcnt(11)
    v_mfma_f32_16x16x32_bf16 v[16:19], v[100:103], v[144:147], v[16:19]
    ds_read_b64 v[130:131], v2 offset:136
    v_mfma_f32_16x16x32_bf16 v[16:19], v[112:115], v[132:135], v[16:19]
    ds_read_b128 v[68:71], v3 offset:64
    v_mfma_f32_16x16x32_bf16 v[20:23], v[104:107], v[144:147], v[20:23]
    ds_read_b64 v[36:37], v2 offset:3648
    v_mfma_f32_16x16x32_bf16 v[20:23], v[112:115], v[136:139], v[20:23]
    ds_read_b64 v[38:39], v2 offset:3656
    v_mfma_f32_16x16x32_bf16 v[24:27], v[108:111], v[144:147], v[24:27]
    v_mfma_f32_16x16x32_bf16 v[24:27], v[112:115], v[140:143], v[24:27]
    v_mfma_f32_16x16x32_bf16 v[28:31], v[112:115], v[144:147], v[28:31]
    s_waitcnt lgkmcnt(12)
    v_mfma_f32_16x16x32_bf16 v[20:23], v[100:103], v[148:151], v[20:23]
    ds_read_b128 v[72:75], v3 offset:576
    v_mfma_f32_16x16x32_bf16 v[20:23], v[116:119], v[132:135], v[20:23]
    ds_read_b64 v[40:41], v2 offset:3136
    v_mfma_f32_16x16x32_bf16 v[24:27], v[104:107], v[148:151], v[24:27]
    ds_read_b64 v[42:43], v2 offset:3144
    v_mfma_f32_16x16x32_bf16 v[24:27], v[116:119], v[136:139], v[24:27]
    v_mfma_f32_16x16x32_bf16 v[28:31], v[108:111], v[148:151], v[28:31]
    v_mfma_f32_16x16x32_bf16 v[28:31], v[116:119], v[140:143], v[28:31]
    v_mfma_f32_16x16x32_bf16 v[32:35], v[112:115], v[148:151], v[32:35]
    v_mfma_f32_16x16x32_bf16 v[32:35], v[116:119], v[144:147], v[32:35]
    s_waitcnt lgkmcnt(12)
    v_mfma_f32_16x16x32_bf16 v[24:27], v[100:103], v[152:155], v[24:27]
    ds_read_b128 v[76:79], v3 offset:1088
    v_mfma_f32_16x16x32_bf16 v[24:27], v[120:123], v[132:135], v[24:27]
    ds_read_b64 v[44:45], v2 offset:2624
    v_mfma_f32_16x16x32_bf16 v[28:31], v[104:107], v[152:155], v[28:31]
    ds_read_b64 v[46:47], v2 offset:2632
    v_mfma_f32_16x16x32_bf16 v[28:31], v[120:123], v[136:139], v[28:31]
    v_mfma_f32_16x16x32_bf16 v[32:35], v[108:111], v[152:155], v[32:35]
    v_mfma_f32_16x16x32_bf16 v[32:35], v[120:123], v[140:143], v[32:35]
    s_waitcnt lgkmcnt(12)
    v_mfma_f32_16x16x32_bf16 v[28:31], v[100:103], v[156:159], v[28:31]
    ds_read_b128 v[80:83], v3 offset:1600
    v_mfma_f32_16x16x32_bf16 v[28:31], v[124:127], v[132:135], v[28:31]
    ds_read_b64 v[48:49], v2 offset:2112
    v_mfma_f32_16x16x32_bf16 v[32:35], v[104:107], v[156:159], v[32:35]
    ds_read_b64 v[50:51], v2 offset:2120
    v_mfma_f32_16x16x32_bf16 v[32:35], v[124:127], v[136:139], v[32:35]
    s_waitcnt lgkmcnt(12)
    v_mfma_f32_16x16x32_bf16 v[32:35], v[100:103], v[160:163], v[32:35]
    ds_read_b128 v[84:87], v3 offset:2112
    v_mfma_f32_16x16x32_bf16 v[32:35], v[128:131], v[132:135], v[32:35]
    ds_read_b64 v[52:53], v2 offset:1600
    s_waitcnt lgkmcnt(11)
    v_mfma_f32_16x16x32_bf16 v[4:7], v[36:39], v[68:71], v[4:7]
    ds_read_b64 v[54:55], v2 offset:1608
    s_waitcnt lgkmcnt(9)
    v_mfma_f32_16x16x32_bf16 v[8:11], v[36:39], v[72:75], v[8:11]
    ds_read_b128 v[88:91], v3 offset:2624
    v_mfma_f32_16x16x32_bf16 v[8:11], v[40:43], v[68:71], v[8:11]
    ds_read_b64 v[56:57], v2 offset:1088
    v_mfma_f32_16x16x32_bf16 v[12:15], v[40:43], v[72:75], v[12:15]
    ds_read_b64 v[58:59], v2 offset:1096
    s_waitcnt lgkmcnt(9)
    v_mfma_f32_16x16x32_bf16 v[12:15], v[36:39], v[76:79], v[12:15]
    ds_read_b128 v[92:95], v3 offset:3136
    v_mfma_f32_16x16x32_bf16 v[12:15], v[44:47], v[68:71], v[12:15]
    ds_read_b64 v[60:61], v2 offset:576
    v_mfma_f32_16x16x32_bf16 v[16:19], v[40:43], v[76:79], v[16:19]
    ds_read_b64 v[62:63], v2 offset:584
    v_mfma_f32_16x16x32_bf16 v[16:19], v[44:47], v[72:75], v[16:19]
    ds_read_b128 v[96:99], v3 offset:3648
    v_mfma_f32_16x16x32_bf16 v[20:23], v[44:47], v[76:79], v[20:23]
    ds_read_b64 v[64:65], v2 offset:64
    s_waitcnt lgkmcnt(11)
    v_mfma_f32_16x16x32_bf16 v[16:19], v[36:39], v[80:83], v[16:19]
    ds_read_b64 v[66:67], v2 offset:72
    v_mfma_f32_16x16x32_bf16 v[16:19], v[48:51], v[68:71], v[16:19]
    ds_read_b128 v[132:135], v3 offset:0
    v_mfma_f32_16x16x32_bf16 v[20:23], v[40:43], v[80:83], v[20:23]
    ds_read_b64 v[100:101], v2 offset:3584
    v_mfma_f32_16x16x32_bf16 v[20:23], v[48:51], v[72:75], v[20:23]
    ds_read_b64 v[102:103], v2 offset:3592
    v_mfma_f32_16x16x32_bf16 v[24:27], v[44:47], v[80:83], v[24:27]
    v_mfma_f32_16x16x32_bf16 v[24:27], v[48:51], v[76:79], v[24:27]
    v_mfma_f32_16x16x32_bf16 v[28:31], v[48:51], v[80:83], v[28:31]
    s_waitcnt lgkmcnt(12)
    v_mfma_f32_16x16x32_bf16 v[20:23], v[36:39], v[84:87], v[20:23]
    ds_read_b128 v[136:139], v3 offset:512
    v_mfma_f32_16x16x32_bf16 v[20:23], v[52:55], v[68:71], v[20:23]
    ds_read_b64 v[104:105], v2 offset:3072
    v_mfma_f32_16x16x32_bf16 v[24:27], v[40:43], v[84:87], v[24:27]
    ds_read_b64 v[106:107], v2 offset:3080
    v_mfma_f32_16x16x32_bf16 v[24:27], v[52:55], v[72:75], v[24:27]
    v_mfma_f32_16x16x32_bf16 v[28:31], v[44:47], v[84:87], v[28:31]
    v_mfma_f32_16x16x32_bf16 v[28:31], v[52:55], v[76:79], v[28:31]
    v_mfma_f32_16x16x32_bf16 v[32:35], v[48:51], v[84:87], v[32:35]
    v_mfma_f32_16x16x32_bf16 v[32:35], v[52:55], v[80:83], v[32:35]
    s_waitcnt lgkmcnt(12)
    v_mfma_f32_16x16x32_bf16 v[24:27], v[36:39], v[88:91], v[24:27]
    ds_read_b128 v[140:143], v3 offset:1024
    v_mfma_f32_16x16x32_bf16 v[24:27], v[56:59], v[68:71], v[24:27]
    ds_read_b64 v[108:109], v2 offset:2560
    v_mfma_f32_16x16x32_bf16 v[28:31], v[40:43], v[88:91], v[28:31]
    ds_read_b64 v[110:111], v2 offset:2568
    v_mfma_f32_16x16x32_bf16 v[28:31], v[56:59], v[72:75], v[28:31]
    v_mfma_f32_16x16x32_bf16 v[32:35], v[44:47], v[88:91], v[32:35]
    v_mfma_f32_16x16x32_bf16 v[32:35], v[56:59], v[76:79], v[32:35]
    s_waitcnt lgkmcnt(12)
    v_mfma_f32_16x16x32_bf16 v[28:31], v[36:39], v[92:95], v[28:31]
    ds_read_b128 v[144:147], v3 offset:1536
    v_mfma_f32_16x16x32_bf16 v[28:31], v[60:63], v[68:71], v[28:31]
    ds_read_b64 v[112:113], v2 offset:2048
    v_mfma_f32_16x16x32_bf16 v[32:35], v[40:43], v[92:95], v[32:35]
    ds_read_b64 v[114:115], v2 offset:2056
    v_mfma_f32_16x16x32_bf16 v[32:35], v[60:63], v[72:75], v[32:35]
    s_waitcnt lgkmcnt(12)
    v_mfma_f32_16x16x32_bf16 v[32:35], v[36:39], v[96:99], v[32:35]
    ds_read_b128 v[148:151], v3 offset:2048
    v_mfma_f32_16x16x32_bf16 v[32:35], v[64:67], v[68:71], v[32:35]
    ds_read_b64 v[116:117], v2 offset:1536
    s_waitcnt lgkmcnt(11)
    v_mfma_f32_16x16x32_bf16 v[4:7], v[100:103], v[132:135], v[4:7]
    ds_read_b64 v[118:119], v2 offset:1544
    s_waitcnt lgkmcnt(9)
    v_mfma_f32_16x16x32_bf16 v[8:11], v[100:103], v[136:139], v[8:11]
    ds_read_b128 v[152:155], v3 offset:2560
    v_mfma_f32_16x16x32_bf16 v[8:11], v[104:107], v[132:135], v[8:11]
    ds_read_b64 v[120:121], v2 offset:1024
    v_mfma_f32_16x16x32_bf16 v[12:15], v[104:107], v[136:139], v[12:15]
    ds_read_b64 v[122:123], v2 offset:1032
    s_waitcnt lgkmcnt(9)
    v_mfma_f32_16x16x32_bf16 v[12:15], v[100:103], v[140:143], v[12:15]
    ds_read_b128 v[156:159], v3 offset:3072
    v_mfma_f32_16x16x32_bf16 v[12:15], v[108:111], v[132:135], v[12:15]
    ds_read_b64 v[124:125], v2 offset:512
    v_mfma_f32_16x16x32_bf16 v[16:19], v[104:107], v[140:143], v[16:19]
    ds_read_b64 v[126:127], v2 offset:520
    v_mfma_f32_16x16x32_bf16 v[16:19], v[108:111], v[136:139], v[16:19]
    ds_read_b128 v[160:163], v3 offset:3584
    v_mfma_f32_16x16x32_bf16 v[20:23], v[108:111], v[140:143], v[20:23]
    ds_read_b64 v[128:129], v2 offset:0
    s_waitcnt lgkmcnt(11)
    v_mfma_f32_16x16x32_bf16 v[16:19], v[100:103], v[144:147], v[16:19]
    ds_read_b64 v[130:131], v2 offset:8
    v_mfma_f32_16x16x32_bf16 v[16:19], v[112:115], v[132:135], v[16:19]
    v_mfma_f32_16x16x32_bf16 v[20:23], v[104:107], v[144:147], v[20:23]
    v_mfma_f32_16x16x32_bf16 v[20:23], v[112:115], v[136:139], v[20:23]
    v_mfma_f32_16x16x32_bf16 v[24:27], v[108:111], v[144:147], v[24:27]
    v_mfma_f32_16x16x32_bf16 v[24:27], v[112:115], v[140:143], v[24:27]
    v_mfma_f32_16x16x32_bf16 v[28:31], v[112:115], v[144:147], v[28:31]
    s_waitcnt lgkmcnt(9)
    v_mfma_f32_16x16x32_bf16 v[20:23], v[100:103], v[148:151], v[20:23]
    v_mfma_f32_16x16x32_bf16 v[20:23], v[116:119], v[132:135], v[20:23]
    v_mfma_f32_16x16x32_bf16 v[24:27], v[104:107], v[148:151], v[24:27]
    v_mfma_f32_16x16x32_bf16 v[24:27], v[116:119], v[136:139], v[24:27]
    v_mfma_f32_16x16x32_bf16 v[28:31], v[108:111], v[148:151], v[28:31]
    v_mfma_f32_16x16x32_bf16 v[28:31], v[116:119], v[140:143], v[28:31]
    v_mfma_f32_16x16x32_bf16 v[32:35], v[112:115], v[148:151], v[32:35]
    v_mfma_f32_16x16x32_bf16 v[32:35], v[116:119], v[144:147], v[32:35]
    s_waitcnt lgkmcnt(6)
    v_mfma_f32_16x16x32_bf16 v[24:27], v[100:103], v[152:155], v[24:27]
    v_mfma_f32_16x16x32_bf16 v[24:27], v[120:123], v[132:135], v[24:27]
    v_mfma_f32_16x16x32_bf16 v[28:31], v[104:107], v[152:155], v[28:31]
    v_mfma_f32_16x16x32_bf16 v[28:31], v[120:123], v[136:139], v[28:31]
    v_mfma_f32_16x16x32_bf16 v[32:35], v[108:111], v[152:155], v[32:35]
    v_mfma_f32_16x16x32_bf16 v[32:35], v[120:123], v[140:143], v[32:35]
    s_waitcnt lgkmcnt(3)
    v_mfma_f32_16x16x32_bf16 v[28:31], v[100:103], v[156:159], v[28:31]
    v_mfma_f32_16x16x32_bf16 v[28:31], v[124:127], v[132:135], v[28:31]
    v_mfma_f32_16x16x32_bf16 v[32:35], v[104:107], v[156:159], v[32:35]
    v_mfma_f32_16x16x32_bf16 v[32:35], v[124:127], v[136:139], v[32:35]
    s_waitcnt lgkmcnt(0)
    v_mfma_f32_16x16x32_bf16 v[32:35], v[100:103], v[160:163], v[32:35]
    v_mfma_f32_16x16x32_bf16 v[32:35], v[128:131], v[132:135], v[32:35]
    s_lshl_b32 s59, s3, 13
    s_add_u32 s59, s59, 9216
    v_lshl_add_u32 v2, v0, 4, s59
    ds_write_b128 v2, v[4:7] offset:0
    ds_write_b128 v2, v[8:11] offset:1024
    ds_write_b128 v2, v[12:15] offset:2048
    ds_write_b128 v2, v[16:19] offset:3072
    ds_write_b128 v2, v[20:23] offset:4096
    ds_write_b128 v2, v[24:27] offset:5120
    ds_write_b128 v2, v[28:31] offset:6144
    ds_write_b128 v2, v[32:35] offset:7168
    s_branch L_convend_25
L_noconv_24:
    s_setprio 2
    v_and_b32 v84, 15, v0
    v_lshrrev_b32 v85, 4, v0
    v_lshrrev_b32 v99, 2, v84
    v_lshrrev_b32 v100, 1, v85
    v_lshl_add_u32 v99, v100, 3, v99
    v_mul_u32_u24 v99, 224, v99
    v_and_b32 v100, 3, v0
    v_lshl_add_u32 v99, v100, 3, v99
    v_and_b32 v100, 1, v85
    v_mul_u32_u24 v100, 7296, v100
    v_add_u32 v99, v99, v100
    s_sub_u32 s71, s3, 4
    s_lshl_b32 s71, s71, 1
    s_lshl_b32 s72, s71, 5
    s_add_u32 s72, s72, 149248
    v_add_u32 v98, s72, v99
    v_lshlrev_b32 v108, 4, v0
    v_lshlrev_b32 v112, 2, v0
    v_mov_b32 v152, 0x3f803f80
    v_mov_b32 v153, 0x3f803f80
    s_lshr_b32 s72, s2, 4
    s_mul_i32 s72, s72, 7
    s_add_u32 s72, s72, s71
    s_lshl_b32 s72, s72, 5
    s_and_b32 s73, s2, 15
    s_lshl_b32 s73, s73, 1
    s_add_u32 s72, s72, s73
    s_lshl_b32 s72, s72, 10
    s_add_u32 s72, s72, 3145728
    s_mul_i32 s74, s2, 896
    s_lshl_b32 s73, s71, 7
    s_add_u32 s74, s74, s73
    s_add_u32 s74, s74, 32768
    ds_read_b64_tr_b16 v[116:117], v98 offset:0
    ds_read_b64_tr_b16 v[118:119], v98 offset:896
    ds_read_b64_tr_b16 v[120:121], v98 offset:3584
    ds_read_b64_tr_b16 v[122:123], v98 offset:4480
    s_cmp_eq_u32 s3, 7
    s_cbranch_scc1 L_prepdone_26_r
    ds_read_b64_tr_b16 v[124:125], v98 offset:32
    ds_read_b64_tr_b16 v[126:127], v98 offset:928
    ds_read_b64_tr_b16 v[128:129], v98 offset:3616
    ds_read_b64_tr_b16 v[130:131], v98 offset:4512
L_prepdone_26_r:
    s_waitcnt lgkmcnt(0)
    s_add_u32 s73, s72, 0
    buffer_store_dwordx4 v[116:119], v108, s[4:7], s73 offen sc1
    buffer_store_dwordx4 v[120:123], v108, s[4:7], s73 offen offset:1024 sc1
    v_mfma_f32_4x4x4_16b_bf16 v[140:143], v[152:153], v[116:117], 0
    s_nop 1
    v_mfma_f32_4x4x4_16b_bf16 v[140:143], v[152:153], v[118:119], v[140:143]
    s_nop 1
    v_mfma_f32_4x4x4_16b_bf16 v[140:143], v[152:153], v[120:121], v[140:143]
    s_nop 1
    v_mfma_f32_4x4x4_16b_bf16 v[140:143], v[152:153], v[122:123], v[140:143]
    s_nop 4
    v_mov_b32 v110, v140
    v_mov_b32 v111, v140
    s_nop 1
    v_permlane32_swap_b32 v110, v111
    v_add_f32 v110, v110, v111
    s_add_u32 s73, s74, 0
    s_mov_b64 s[90:91], exec
    s_mov_b32 exec_hi, 0
    buffer_store_dword v110, v112, s[4:7], s73 offen sc1
    s_mov_b64 exec, s[90:91]
    s_cmp_eq_u32 s3, 7
    s_cbranch_scc1 L_prepdone_26
    s_add_u32 s73, s72, 32768
    buffer_store_dwordx4 v[124:127], v108, s[4:7], s73 offen sc1
    buffer_store_dwordx4 v[128:131], v108, s[4:7], s73 offen offset:1024 sc1
    v_mfma_f32_4x4x4_16b_bf16 v[144:147], v[152:153], v[124:125], 0
    s_nop 1
    v_mfma_f32_4x4x4_16b_bf16 v[144:147], v[152:153], v[126:127], v[144:147]
    s_nop 1
    v_mfma_f32_4x4x4_16b_bf16 v[144:147], v[152:153], v[128:129], v[144:147]
    s_nop 1
    v_mfma_f32_4x4x4_16b_bf16 v[144:147], v[152:153], v[130:131], v[144:147]
    s_nop 4
    v_mov_b32 v110, v144
    v_mov_b32 v111, v144
    s_nop 1
    v_permlane32_swap_b32 v110, v111
    v_add_f32 v110, v110, v111
    s_add_u32 s73, s74, 128
    s_mov_b64 s[90:91], exec
    s_mov_b32 exec_hi, 0
    buffer_store_dword v110, v112, s[4:7], s73 offen sc1
    s_mov_b64 exec, s[90:91]
L_prepdone_26:
    s_setprio 0
    v_mov_b32 v40, 163784
    v_mov_b32 v41, 1
    s_waitcnt vmcnt(0)
    s_mov_b64 s[90:91], exec
    s_mov_b64 exec, 1
    ds_add_rtn_u32 v42, v40, v41
    s_waitcnt lgkmcnt(0)
    v_readfirstlane_b32 s56, v42
    s_nop 1
    s_cmp_eq_u32 s56, 3
    s_cbranch_scc0 L_notlast_27
    s_and_b32 s56, s2, 15
    s_lshl_b32 s56, s56, 8
    s_add_u32 s56, s56, 282624
    v_mov_b32 v40, 1
    v_mov_b32 v41, 0
    buffer_atomic_add v40, v41, s[4:7], s56 offen
L_notlast_27:
    s_mov_b64 exec, s[90:91]
    s_cmp_eq_u32 s3, 7
    s_cbranch_scc0 L_notouch_28
    s_mov_b32 s12, s40
    s_mov_b32 s13, s41
    s_mov_b32 s14, 1835008
    s_mov_b32 s15, 0x20000
    s_mul_i32 s60, s2, 7168
    v_lshlrev_b32 v10, 4, v0
    buffer_load_dwordx4 v[200:203], v10, s[12:15], s60 offen offset:0
    buffer_load_dwordx4 v[200:203], v10, s[12:15], s60 offen offset:1024
    buffer_load_dwordx4 v[200:203], v10, s[12:15], s60 offen offset:2048
    buffer_load_dwordx4 v[200:203], v10, s[12:15], s60 offen offset:3072
    s_add_u32 s60, s60, 4096
    buffer_load_dwordx4 v[200:203], v10, s[12:15], s60 offen offset:0
    buffer_load_dwordx4 v[200:203], v10, s[12:15], s60 offen offset:1024
    buffer_load_dwordx4 v[200:203], v10, s[12:15], s60 offen offset:2048
L_notouch_28:
L_convend_25:
    s_waitcnt lgkmcnt(0)
    s_barrier
    s_lshr_b32 s57, s3, 2
    s_and_b32 s58, s3, 3
    s_lshl_b32 s59, s57, 14
    s_lshl_b32 s60, s58, 11
    s_add_u32 s59, s59, s60
    s_add_u32 s59, s59, 9216
    v_lshl_add_u32 v2, v0, 4, s59
    ds_read_b128 v[4:7], v2 offset:0
    ds_read_b128 v[8:11], v2 offset:8192
    ds_read_b128 v[12:15], v2 offset:1024
    ds_read_b128 v[16:19], v2 offset:9216
    v_and_b32 v20, 15, v0
    v_lshrrev_b32 v21, 4, v0
    v_lshlrev_b32 v20, 5, v20
    v_lshl_add_u32 v20, v21, 3, v20
    s_lshl_b32 s60, s58, 10
    v_add_u32 v20, s60, v20
    s_mul_i32 s61, s57, 4608
    s_add_u32 s61, s61, 512
    v_add_u32 v21, s61, v20
    s_lshl_b32 s61, s57, 12
    s_add_u32 s61, s61, 41984
    v_add_u32 v22, s61, v20
    ds_read_b64 v[24:25], v21 offset:0
    ds_read_b64 v[26:27], v22 offset:0
    ds_read_b64 v[28:29], v21 offset:512
    ds_read_b64 v[30:31], v22 offset:512
    s_lshl_b32 s62, s81, 16
    s_and_b32 s63, s81, 0xffff0000
    s_cmp_eq_u32 s57, 0
    s_cselect_b32 s62, s62, s63
    s_lshl_b32 s63, s50, 1
    s_add_u32 s63, s63, s57
    s_lshl_b32 s63, s63, 12
    s_add_u32 s63, s63, 1048576
    s_waitcnt lgkmcnt(0)
    v_add_f32 v4, v4, v8
    v_add_f32 v5, v5, v9
    v_add_f32 v6, v6, v10
    v_add_f32 v7, v7, v11
    v_add_f32 v12, v12, v16
    v_add_f32 v13, v13, v17
    v_add_f32 v14, v14, v18
    v_add_f32 v15, v15, v19
    v_lshlrev_b32 v32, 16, v26
    v_and_b32 v33, 0xffff0000, v26
    v_lshlrev_b32 v36, 16, v24
    v_and_b32 v37, 0xffff0000, v24
    v_lshlrev_b32 v34, 16, v27
    v_and_b32 v35, 0xffff0000, v27
    v_lshlrev_b32 v38, 16, v25
    v_and_b32 v39, 0xffff0000, v25
    v_lshlrev_b32 v44, 16, v30
    v_and_b32 v45, 0xffff0000, v30
    v_lshlrev_b32 v48, 16, v28
    v_and_b32 v49, 0xffff0000, v28
    v_lshlrev_b32 v46, 16, v31
    v_and_b32 v47, 0xffff0000, v31
    v_lshlrev_b32 v50, 16, v29
    v_and_b32 v51, 0xffff0000, v29
    v_fmac_f32 v4, s62, v36
    v_fmac_f32 v5, s62, v37
    v_fmac_f32 v6, s62, v38
    v_fmac_f32 v7, s62, v39
    v_fmac_f32 v12, s62, v48
    v_fmac_f32 v13, s62, v49
    v_fmac_f32 v14, s62, v50
    v_fmac_f32 v15, s62, v51
    v_add_f32 v4, v4, v32
    v_add_f32 v5, v5, v33
    v_add_f32 v6, v6, v34
    v_add_f32 v7, v7, v35
    v_add_f32 v12, v12, v44
    v_add_f32 v13, v13, v45
    v_add_f32 v14, v14, v46
    v_add_f32 v15, v15, v47
    v_cvt_pk_bf16_f32 v56, v4, v5
    v_cvt_pk_bf16_f32 v57, v6, v7
    v_cvt_pk_bf16_f32 v58, v12, v13
    v_cvt_pk_bf16_f32 v59, v14, v15
    s_nop 0
    v_permlane16_swap_b32 v56, v58
    v_permlane16_swap_b32 v57, v59
    v_and_b32 v20, 15, v0
    v_lshlrev_b32 v20, 5, v20
    v_lshrrev_b32 v21, 5, v0
    v_lshl_add_u32 v20, v21, 4, v20
    v_bfe_u32 v21, v0, 4, 1
    v_lshl_add_u32 v20, v21, 9, v20
    v_add_u32 v20, s60, v20
    buffer_store_dwordx4 v[56:59], v20, s[4:7], s63 offen sc1
    s_cmp_eq_u32 s3, 4
    s_cbranch_scc0 L_wlook_29
    v_min_u32 v17, 15, v0
    s_mov_b32 s55, 256
    v_mul_lo_u32 v17, v17, s55
    s_mov_b32 s56, 282624
    s_mov_b32 s83, 0
L_poll_w_30:
    buffer_load_dword v16, v17, s[4:7], s56 offen sc1
    s_add_u32 s83, s83, 1
    s_waitcnt vmcnt(0)
    v_cmp_gt_u32 vcc, 16, v16
    s_cmp_ge_u32 s83, 30000
    s_cbranch_scc1 L_polld_w_31
    s_cbranch_vccz L_polld_w_31
    s_sleep 4
    s_branch L_poll_w_30
L_polld_w_31:
L_wlook_29:
    s_waitcnt vmcnt(0)
    s_barrier
    s_cmp_eq_u32 s3, 7
    s_cbranch_scc0 L_arr2_32
    s_and_b32 s56, s2, 15
    s_lshl_b32 s56, s56, 8
    s_add_u32 s56, s56, 266240
    v_mov_b32 v16, 1
    v_mov_b32 v17, 0
    s_mov_b64 s[90:91], exec
    s_mov_b64 exec, 1
    buffer_atomic_add v16, v17, s[4:7], s56 offen
    s_mov_b64 exec, s[90:91]
L_arr2_32:
    s_lshr_b32 s75, s3, 2
    s_and_b32 s76, s3, 3
    s_mul_i32 s77, s52, 229376
    s_add_u32 s77, s77, 3145728
    s_lshl_b32 s55, s51, 2
    s_add_u32 s55, s55, s76
    s_mul_i32 s55, s55, 112
    s_mul_i32 s56, s52, 7
    s_add_u32 s55, s55, s56
    s_lshl_b32 s55, s55, 10
    s_add_u32 s78, s55, 7340032
    v_lshlrev_b32 v7, 4, v0
    v_lshrrev_b32 v14, 4, v0
    v_and_b32 v15, 15, v0
    v_lshlrev_b32 v13, 2, v14
    v_xor_b32 v13, v13, v15
    v_lshlrev_b32 v13, 4, v13
    s_lshl_b32 s55, s3, 2
    v_add_u32 v14, s55, v14
    v_lshl_add_u32 v13, v14, 12, v13
    s_lshl_b32 s55, s51, 8
    v_add_u32 v13, s55, v13
    v_lshrrev_b32 v80, 2, v15
    v_lshrrev_b32 v81, 5, v0
    v_lshl_add_u32 v81, v81, 3, v80
    v_lshlrev_b32 v2, 8, v81
    v_xor_b32 v80, s76, v80
    v_lshlrev_b32 v80, 2, v80
    v_bfe_u32 v81, v0, 4, 1
    v_lshl_add_u32 v80, v81, 1, v80
    v_bfe_u32 v81, v0, 1, 1
    v_add_u32 v80, v80, v81
    v_lshl_add_u32 v2, v80, 4, v2
    v_and_b32 v80, 1, v0
    v_lshl_add_u32 v2, v80, 3, v2
    s_mul_i32 s55, s75, 32768
    s_add_u32 s55, s55, 50176
    v_add_u32 v3, s55, v7
    v_lshrrev_b32 v14, 5, v0
    v_lshlrev_b32 v14, 4, v14
    v_add_u32 v12, 148992, v14
    v_mov_b32 v8, 0
    v_mov_b32 v9, 0
    v_mov_b32 v10, 0
    v_mov_b32 v11, 0
    s_mov_b32 s8, s40
    s_mov_b32 s9, s41
    s_mov_b32 s10, 1835008
    s_mov_b32 s11, 0x20000
    v_lshrrev_b32 v14, 3, v0
    v_bfe_u32 v15, v0, 4, 1
    v_lshlrev_b32 v15, 2, v15
    v_and_b32 v112, 7, v0
    v_xor_b32 v112, v112, v15
    v_lshlrev_b32 v112, 4, v112
    v_lshl_add_u32 v112, v14, 10, v112
    s_lshl_b32 s56, s54, 7
    v_add_u32 v112, s56, v112
    s_lshl_b32 s72, s76, 13
    s_add_u32 s71, s77, s72
    s_lshl_b32 s74, s76, 12
    s_mul_i32 s73, s76, 114688
    s_barrier
    s_cmp_eq_u32 s3, 7
    s_cbranch_scc1 L_p3w7_33
    s_cmp_ge_u32 s3, 4
    s_cbranch_scc1 L_S6_34
    s_lshl_b32 s56, s3, 14
    s_add_u32 s55, s77, s56
    s_add_u32 m0, s56, 50176
    s_nop 0
    buffer_load_dwordx4 v7, s[4:7], s55 offen offset:0 lds
    buffer_load_dwordx4 v7, s[4:7], s55 offen offset:1024 lds
    buffer_load_dwordx4 v7, s[4:7], s55 offen offset:2048 lds
    buffer_load_dwordx4 v7, s[4:7], s55 offen offset:3072 lds
    s_add_u32 m0, m0, 4096
    s_add_u32 s55, s55, 4096
    buffer_load_dwordx4 v7, s[4:7], s55 offen offset:0 lds
    buffer_load_dwordx4 v7, s[4:7], s55 offen offset:1024 lds
    buffer_load_dwordx4 v7, s[4:7], s55 offen offset:2048 lds
    buffer_load_dwordx4 v7, s[4:7], s55 offen offset:3072 lds
    s_add_u32 m0, m0, 4096
    s_add_u32 s55, s55, 4096
    buffer_load_dwordx4 v7, s[4:7], s55 offen offset:0 lds
    buffer_load_dwordx4 v7, s[4:7], s55 offen offset:1024 lds
    buffer_load_dwordx4 v7, s[4:7], s55 offen offset:2048 lds
    buffer_load_dwordx4 v7, s[4:7], s55 offen offset:3072 lds
    s_add_u32 m0, m0, 4096
    s_add_u32 s55, s55, 4096
    buffer_load_dwordx4 v7, s[4:7], s55 offen offset:0 lds
    buffer_load_dwordx4 v7, s[4:7], s55 offen offset:1024 lds
    buffer_load_dwordx4 v7, s[4:7], s55 offen offset:2048 lds
    buffer_load_dwordx4 v7, s[4:7], s55 offen offset:3072 lds
    s_mul_i32 s55, s52, 14336
    s_add_u32 s55, s55, 32768
    v_lshlrev_b32 v14, 2, v1
    v_min_u32 v14, 892, v14
    buffer_load_dword v96, v14, s[4:7], s55 offen
    s_add_u32 s55, s55, 896
    buffer_load_dword v97, v14, s[4:7], s55 offen
    s_add_u32 s55, s55, 896
    buffer_load_dword v98, v14, s[4:7], s55 offen
    s_add_u32 s55, s55, 896
    buffer_load_dword v99, v14, s[4:7], s55 offen
    s_add_u32 s55, s55, 896
    buffer_load_dword v100, v14, s[4:7], s55 offen
    s_add_u32 s55, s55, 896
    buffer_load_dword v101, v14, s[4:7], s55 offen
    s_add_u32 s55, s55, 896
    buffer_load_dword v102, v14, s[4:7], s55 offen
    s_add_u32 s55, s55, 896
    buffer_load_dword v103, v14, s[4:7], s55 offen
    s_add_u32 s55, s55, 896
    buffer_load_dword v104, v14, s[4:7], s55 offen
    s_add_u32 s55, s55, 896
    buffer_load_dword v105, v14, s[4:7], s55 offen
    s_add_u32 s55, s55, 896
    buffer_load_dword v106, v14, s[4:7], s55 offen
    s_add_u32 s55, s55, 896
    buffer_load_dword v107, v14, s[4:7], s55 offen
    s_add_u32 s55, s55, 896
    buffer_load_dword v108, v14, s[4:7], s55 offen
    s_add_u32 s55, s55, 896
    buffer_load_dword v109, v14, s[4:7], s55 offen
    s_add_u32 s55, s55, 896
    buffer_load_dword v110, v14, s[4:7], s55 offen
    s_add_u32 s55, s55, 896
    buffer_load_dword v111, v14, s[4:7], s55 offen
    s_branch L_S6_34
L_p3w7_33:
    v_min_u32 v17, 15, v0
    s_mov_b32 s55, 256
    v_mul_lo_u32 v17, v17, s55
    s_mov_b32 s56, 266240
    s_mov_b32 s83, 0
L_poll_b2_35:
    buffer_load_dword v16, v17, s[4:7], s56 offen sc1
    s_add_u32 s83, s83, 1
    s_waitcnt vmcnt(0)
    v_cmp_gt_u32 vcc, 16, v16
    s_cmp_ge_u32 s83, 30000
    s_cbranch_scc1 L_polld_b2_36
    s_cbranch_vccz L_polld_b2_36
    s_sleep 4
    s_branch L_poll_b2_35
L_polld_b2_36:
    s_and_b32 s56, s52, 7
    s_lshl_b32 s56, s56, 18
    s_lshl_b32 s55, s51, 8
    s_add_u32 s55, s55, s56
    s_add_u32 s55, s55, 1048576
    v_lshlrev_b32 v20, 12, v0
    buffer_load_dword v21, v20, s[4:7], s55 offen
    buffer_load_dword v21, v20, s[4:7], s55 offen offset:128
    s_cmp_eq_u32 s2, 0
    s_cbranch_scc0 L_noep_37
    v_mov_b32 v16, s84
    v_mov_b32 v17, 0
    s_mov_b32 s56, 0
    s_mov_b64 s[90:91], exec
    s_mov_b64 exec, 1
    buffer_store_dword v16, v17, s[4:7], s56 offen sc1
    s_mov_b64 exec, s[90:91]
L_noep_37:
L_S6_34:
    s_barrier
    s_lshl_b32 s56, s3, 10
    s_add_u32 m0, s56, 0
    s_mov_b32 s55, 1048576
    buffer_load_dwordx4 v13, s[4:7], s55 offen lds
    s_lshl_b32 s56, s3, 10
    s_add_u32 m0, s56, 8192
    s_mov_b32 s55, 1179648
    buffer_load_dwordx4 v13, s[4:7], s55 offen lds
    s_lshl_b32 s56, s3, 10
    s_add_u32 m0, s56, 16384
    s_mov_b32 s55, 1310720
    buffer_load_dwordx4 v13, s[4:7], s55 offen lds
    s_lshl_b32 s56, s3, 10
    s_add_u32 m0, s56, 24576
    s_mov_b32 s55, 1441792
    buffer_load_dwordx4 v13, s[4:7], s55 offen lds
    s_lshl_b32 s56, s3, 10
    s_add_u32 m0, s56, 32768
    s_mov_b32 s55, 1572864
    buffer_load_dwordx4 v13, s[4:7], s55 offen lds
    s_cmp_eq_u32 s75, 0
    s_cbranch_scc0 L_grpB_38
    v_mov_b32 v124, 0x3f803f80
    v_mov_b32 v125, 0x3f803f80
    s_waitcnt vmcnt(4) lgkmcnt(0)
    s_barrier
    ds_read_b64_tr_b16 v[128:129], v2 offset:0
    ds_read_b64_tr_b16 v[130:131], v2 offset:1024
    ds_read_b128 v[48:51], v3 offset:0
    ds_read_b64_tr_b16 v[132:133], v2 offset:4096
    ds_read_b64_tr_b16 v[134:135], v2 offset:5120
    ds_read_b128 v[52:55], v3 offset:1024
    s_lshl_b32 s56, s3, 10
    s_add_u32 m0, s56, 40960
    s_mov_b32 s55, 1703936
    buffer_load_dwordx4 v13, s[4:7], s55 offen lds
    v_add_f32 v96, v96, v104
    v_add_f32 v97, v97, v105
    v_add_f32 v98, v98, v106
    v_add_f32 v99, v99, v107
    v_add_f32 v100, v100, v108
    v_add_f32 v101, v101, v109
    v_add_f32 v102, v102, v110
    v_add_f32 v103, v103, v111
    v_add_f32 v96, v96, v100
    v_add_f32 v97, v97, v101
    v_add_f32 v98, v98, v102
    v_add_f32 v99, v99, v103
    v_add_f32 v96, v96, v98
    v_add_f32 v97, v97, v99
    v_add_f32 v96, v96, v97
    v_lshlrev_b32 v14, 2, v1
    v_min_u32 v14, 892, v14
    v_add_u32 v14, 148992, v14
    ds_write_b32 v14, v96
    s_waitcnt vmcnt(4) lgkmcnt(0)
    s_barrier
    v_mfma_f32_32x32x16_bf16 v[16:31], v[48:51], v[128:131], 0
    ds_read_b64_tr_b16 v[136:137], v2 offset:8192
    ds_read_b64_tr_b16 v[138:139], v2 offset:9216
    ds_read_b128 v[56:59], v3 offset:2048
    ds_read_b64_tr_b16 v[140:141], v2 offset:12288
    ds_read_b64_tr_b16 v[142:143], v2 offset:13312
    ds_read_b128 v[60:63], v3 offset:3072
    v_mfma_f32_4x4x4_16b_bf16 v[116:119], v[124:125], v[128:129], 0
    v_mfma_f32_4x4x4_16b_bf16 v[120:123], v[128:129], v[128:129], 0
    v_mfma_f32_32x32x16_bf16 v[16:31], v[52:55], v[132:135], v[16:31]
    v_mfma_f32_4x4x4_16b_bf16 v[116:119], v[124:125], v[132:133], v[116:119]
    v_mfma_f32_4x4x4_16b_bf16 v[120:123], v[132:133], v[132:133], v[120:123]
    s_lshl_b32 s56, s3, 10
    s_add_u32 m0, s56, 0
    s_mov_b32 s55, 1835008
    buffer_load_dwordx4 v13, s[4:7], s55 offen lds
    s_waitcnt vmcnt(4) lgkmcnt(0)
    s_barrier
    v_mfma_f32_32x32x16_bf16 v[16:31], v[56:59], v[136:139], v[16:31]
    ds_read_b64_tr_b16 v[144:145], v2 offset:16384
    ds_read_b64_tr_b16 v[146:147], v2 offset:17408
    ds_read_b128 v[48:51], v3 offset:4096
    ds_read_b64_tr_b16 v[148:149], v2 offset:20480
    ds_read_b64_tr_b16 v[150:151], v2 offset:21504
    ds_read_b128 v[52:55], v3 offset:5120
    v_mfma_f32_4x4x4_16b_bf16 v[116:119], v[124:125], v[136:137], v[116:119]
    v_mfma_f32_4x4x4_16b_bf16 v[120:123], v[136:137], v[136:137], v[120:123]
    v_mfma_f32_32x32x16_bf16 v[16:31], v[60:63], v[140:143], v[16:31]
    v_mfma_f32_4x4x4_16b_bf16 v[116:119], v[124:125], v[140:141], v[116:119]
    v_mfma_f32_4x4x4_16b_bf16 v[120:123], v[140:141], v[140:141], v[120:123]
    s_lshl_b32 s56, s3, 10
    s_add_u32 m0, s56, 8192
    s_mov_b32 s55, 1966080
    buffer_load_dwordx4 v13, s[4:7], s55 offen lds
    s_waitcnt vmcnt(4) lgkmcnt(0)
    s_barrier
    v_mfma_f32_32x32x16_bf16 v[16:31], v[48:51], v[144:147], v[16:31]
    ds_read_b64_tr_b16 v[152:153], v2 offset:24576
    ds_read_b64_tr_b16 v[154:155], v2 offset:25600
    ds_read_b128 v[56:59], v3 offset:6144
    ds_read_b64_tr_b16 v[156:157], v2 offset:28672
    ds_read_b64_tr_b16 v[158:159], v2 offset:29696
    ds_read_b128 v[60:63], v3 offset:7168
    v_mfma_f32_4x4x4_16b_bf16 v[116:119], v[124:125], v[144:145], v[116:119]
    v_mfma_f32_4x4x4_16b_bf16 v[120:123], v[144:145], v[144:145], v[120:123]
    v_mfma_f32_32x32x16_bf16 v[16:31], v[52:55], v[148:151], v[16:31]
    v_mfma_f32_4x4x4_16b_bf16 v[116:119], v[124:125], v[148:149], v[116:119]
    v_mfma_f32_4x4x4_16b_bf16 v[120:123], v[148:149], v[148:149], v[120:123]
    s_lshl_b32 s56, s3, 10
    s_add_u32 m0, s56, 16384
    s_mov_b32 s55, 2097152
    buffer_load_dwordx4 v13, s[4:7], s55 offen lds
    s_lshl_b32 s56, s3, 12
    s_add_u32 s55, s77, s56
    s_add_u32 s55, s55, 65536
    s_add_u32 m0, s56, 115712
    s_nop 0
    buffer_load_dwordx4 v7, s[4:7], s55 offen offset:0 lds
    buffer_load_dwordx4 v7, s[4:7], s55 offen offset:1024 lds
    buffer_load_dwordx4 v7, s[4:7], s55 offen offset:2048 lds
    buffer_load_dwordx4 v7, s[4:7], s55 offen offset:3072 lds
    s_waitcnt vmcnt(8) lgkmcnt(0)
    s_barrier
    v_mfma_f32_32x32x16_bf16 v[16:31], v[56:59], v[152:155], v[16:31]
    ds_read_b64_tr_b16 v[160:161], v2 offset:32768
    ds_read_b64_tr_b16 v[162:163], v2 offset:33792
    ds_read_b128 v[48:51], v3 offset:8192
    ds_read_b64_tr_b16 v[164:165], v2 offset:36864
    ds_read_b64_tr_b16 v[166:167], v2 offset:37888
    ds_read_b128 v[52:55], v3 offset:9216
    v_mfma_f32_4x4x4_16b_bf16 v[116:119], v[124:125], v[152:153], v[116:119]
    v_mfma_f32_4x4x4_16b_bf16 v[120:123], v[152:153], v[152:153], v[120:123]
    v_mfma_f32_32x32x16_bf16 v[16:31], v[60:63], v[156:159], v[16:31]
    v_mfma_f32_4x4x4_16b_bf16 v[116:119], v[124:125], v[156:157], v[116:119]
    v_mfma_f32_4x4x4_16b_bf16 v[120:123], v[156:157], v[156:157], v[120:123]
    s_lshl_b32 s56, s3, 10
    s_add_u32 m0, s56, 24576
    s_mov_b32 s55, 2228224
    buffer_load_dwordx4 v13, s[4:7], s55 offen lds
    s_waitcnt vmcnt(8) lgkmcnt(0)
    s_barrier
    v_mfma_f32_32x32x16_bf16 v[16:31], v[48:51], v[160:163], v[16:31]
    ds_read_b64_tr_b16 v[168:169], v2 offset:40960
    ds_read_b64_tr_b16 v[170:171], v2 offset:41984
    ds_read_b128 v[56:59], v3 offset:10240
    ds_read_b64_tr_b16 v[172:173], v2 offset:45056
    ds_read_b64_tr_b16 v[174:175], v2 offset:46080
    ds_read_b128 v[60:63], v3 offset:11264
    v_mfma_f32_4x4x4_16b_bf16 v[116:119], v[124:125], v[160:161], v[116:119]
    v_mfma_f32_4x4x4_16b_bf16 v[120:123], v[160:161], v[160:161], v[120:123]
    v_mfma_f32_32x32x16_bf16 v[16:31], v[52:55], v[164:167], v[16:31]
    v_mfma_f32_4x4x4_16b_bf16 v[116:119], v[124:125], v[164:165], v[116:119]
    v_mfma_f32_4x4x4_16b_bf16 v[120:123], v[164:165], v[164:165], v[120:123]
    s_lshl_b32 s56, s3, 10
    s_add_u32 m0, s56, 32768
    s_mov_b32 s55, 2359296
    buffer_load_dwordx4 v13, s[4:7], s55 offen lds
    s_waitcnt vmcnt(8) lgkmcnt(0)
    s_barrier
    v_mfma_f32_32x32x16_bf16 v[16:31], v[56:59], v[168:171], v[16:31]
    ds_read_b64_tr_b16 v[176:177], v2 offset:0
    ds_read_b64_tr_b16 v[178:179], v2 offset:1024
    ds_read_b128 v[48:51], v3 offset:12288
    ds_read_b64_tr_b16 v[180:181], v2 offset:4096
    ds_read_b64_tr_b16 v[182:183], v2 offset:5120
    ds_read_b128 v[52:55], v3 offset:13312
    v_mfma_f32_4x4x4_16b_bf16 v[116:119], v[124:125], v[168:169], v[116:119]
    v_mfma_f32_4x4x4_16b_bf16 v[120:123], v[168:169], v[168:169], v[120:123]
    v_mfma_f32_32x32x16_bf16 v[16:31], v[60:63], v[172:175], v[16:31]
    v_mfma_f32_4x4x4_16b_bf16 v[116:119], v[124:125], v[172:173], v[116:119]
    v_mfma_f32_4x4x4_16b_bf16 v[120:123], v[172:173], v[172:173], v[120:123]
    s_lshl_b32 s56, s3, 10
    s_add_u32 m0, s56, 40960
    s_mov_b32 s55, 2490368
    buffer_load_dwordx4 v13, s[4:7], s55 offen lds
    s_waitcnt vmcnt(8) lgkmcnt(0)
    s_barrier
    v_mfma_f32_32x32x16_bf16 v[16:31], v[48:51], v[176:179], v[16:31]
    ds_read_b64_tr_b16 v[184:185], v2 offset:8192
    ds_read_b64_tr_b16 v[186:187], v2 offset:9216
    ds_read_b128 v[56:59], v3 offset:14336
    ds_read_b64_tr_b16 v[188:189], v2 offset:12288
    ds_read_b64_tr_b16 v[190:191], v2 offset:13312
    ds_read_b128 v[60:63], v3 offset:15360
    v_mfma_f32_4x4x4_16b_bf16 v[116:119], v[124:125], v[176:177], v[116:119]
    v_mfma_f32_4x4x4_16b_bf16 v[120:123], v[176:177], v[176:177], v[120:123]
    v_mfma_f32_32x32x16_bf16 v[16:31], v[52:55], v[180:183], v[16:31]
    v_mfma_f32_4x4x4_16b_bf16 v[116:119], v[124:125], v[180:181], v[116:119]
    v_mfma_f32_4x4x4_16b_bf16 v[120:123], v[180:181], v[180:181], v[120:123]
    s_lshl_b32 s56, s3, 10
    s_add_u32 m0, s56, 0
    s_mov_b32 s55, 2621440
    buffer_load_dwordx4 v13, s[4:7], s55 offen lds
    s_waitcnt vmcnt(8) lgkmcnt(0)
    s_barrier
    v_mfma_f32_32x32x16_bf16 v[16:31], v[56:59], v[184:187], v[16:31]
    ds_read_b64_tr_b16 v[192:193], v2 offset:16384
    ds_read_b64_tr_b16 v[194:195], v2 offset:17408
    ds_read_b128 v[48:51], v3 offset:16384
    ds_read_b64_tr_b16 v[196:197], v2 offset:20480
    ds_read_b64_tr_b16 v[198:199], v2 offset:21504
    ds_read_b128 v[52:55], v3 offset:17408
    v_mfma_f32_4x4x4_16b_bf16 v[116:119], v[124:125], v[184:185], v[116:119]
    v_mfma_f32_4x4x4_16b_bf16 v[120:123], v[184:185], v[184:185], v[120:123]
    v_mfma_f32_32x32x16_bf16 v[16:31], v[60:63], v[188:191], v[16:31]
    v_mfma_f32_4x4x4_16b_bf16 v[116:119], v[124:125], v[188:189], v[116:119]
    v_mfma_f32_4x4x4_16b_bf16 v[120:123], v[188:189], v[188:189], v[120:123]
    s_lshl_b32 s56, s3, 10
    s_add_u32 m0, s56, 8192
    s_mov_b32 s55, 2752512
    buffer_load_dwordx4 v13, s[4:7], s55 offen lds
    s_waitcnt vmcnt(4) lgkmcnt(0)
    s_barrier
    v_mfma_f32_32x32x16_bf16 v[16:31], v[48:51], v[192:195], v[16:31]
    ds_read_b64_tr_b16 v[200:201], v2 offset:24576
    ds_read_b64_tr_b16 v[202:203], v2 offset:25600
    ds_read_b128 v[56:59], v3 offset:18432
    ds_read_b64_tr_b16 v[204:205], v2 offset:28672
    ds_read_b64_tr_b16 v[206:207], v2 offset:29696
    ds_read_b128 v[60:63], v3 offset:19456
    v_mfma_f32_4x4x4_16b_bf16 v[116:119], v[124:125], v[192:193], v[116:119]
    v_mfma_f32_4x4x4_16b_bf16 v[120:123], v[192:193], v[192:193], v[120:123]
    v_mfma_f32_32x32x16_bf16 v[16:31], v[52:55], v[196:199], v[16:31]
    v_mfma_f32_4x4x4_16b_bf16 v[116:119], v[124:125], v[196:197], v[116:119]
    v_mfma_f32_4x4x4_16b_bf16 v[120:123], v[196:197], v[196:197], v[120:123]
    s_lshl_b32 s56, s3, 10
    s_add_u32 m0, s56, 16384
    s_mov_b32 s55, 2883584
    buffer_load_dwordx4 v13, s[4:7], s55 offen lds
    s_waitcnt vmcnt(4) lgkmcnt(0)
    s_barrier
    v_mfma_f32_32x32x16_bf16 v[16:31], v[56:59], v[200:203], v[16:31]
    ds_read_b64_tr_b16 v[208:209], v2 offset:32768
    ds_read_b64_tr_b16 v[210:211], v2 offset:33792
    ds_read_b128 v[48:51], v3 offset:20480
    ds_read_b64_tr_b16 v[212:213], v2 offset:36864
    ds_read_b64_tr_b16 v[214:215], v2 offset:37888
    ds_read_b128 v[52:55], v3 offset:21504
    v_mfma_f32_4x4x4_16b_bf16 v[116:119], v[124:125], v[200:201], v[116:119]
    v_mfma_f32_4x4x4_16b_bf16 v[120:123], v[200:201], v[200:201], v[120:123]
    v_mfma_f32_32x32x16_bf16 v[16:31], v[60:63], v[204:207], v[16:31]
    v_mfma_f32_4x4x4_16b_bf16 v[116:119], v[124:125], v[204:205], v[116:119]
    v_mfma_f32_4x4x4_16b_bf16 v[120:123], v[204:205], v[204:205], v[120:123]
    s_lshl_b32 s56, s3, 10
    s_add_u32 m0, s56, 24576
    s_mov_b32 s55, 3014656
    buffer_load_dwordx4 v13, s[4:7], s55 offen lds
    s_waitcnt vmcnt(4) lgkmcnt(0)
    s_barrier
    v_mfma_f32_32x32x16_bf16 v[16:31], v[48:51], v[208:211], v[16:31]
    ds_read_b64_tr_b16 v[216:217], v2 offset:40960
    ds_read_b64_tr_b16 v[218:219], v2 offset:41984
    ds_read_b128 v[56:59], v3 offset:22528
    ds_read_b64_tr_b16 v[220:221], v2 offset:45056
    ds_read_b64_tr_b16 v[222:223], v2 offset:46080
    ds_read_b128 v[60:63], v3 offset:23552
    v_mfma_f32_4x4x4_16b_bf16 v[116:119], v[124:125], v[208:209], v[116:119]
    v_mfma_f32_4x4x4_16b_bf16 v[120:123], v[208:209], v[208:209], v[120:123]
    v_mfma_f32_32x32x16_bf16 v[16:31], v[52:55], v[212:215], v[16:31]
    v_mfma_f32_4x4x4_16b_bf16 v[116:119], v[124:125], v[212:213], v[116:119]
    v_mfma_f32_4x4x4_16b_bf16 v[120:123], v[212:213], v[212:213], v[120:123]
    s_waitcnt vmcnt(3) lgkmcnt(0)
    s_barrier
    v_mfma_f32_32x32x16_bf16 v[16:31], v[56:59], v[216:219], v[16:31]
    ds_read_b64_tr_b16 v[224:225], v2 offset:0
    ds_read_b64_tr_b16 v[226:227], v2 offset:1024
    ds_read_b128 v[48:51], v3 offset:24576
    ds_read_b64_tr_b16 v[228:229], v2 offset:4096
    ds_read_b64_tr_b16 v[230:231], v2 offset:5120
    ds_read_b128 v[52:55], v3 offset:25600
    v_mfma_f32_4x4x4_16b_bf16 v[116:119], v[124:125], v[216:217], v[116:119]
    v_mfma_f32_4x4x4_16b_bf16 v[120:123], v[216:217], v[216:217], v[120:123]
    v_mfma_f32_32x32x16_bf16 v[16:31], v[60:63], v[220:223], v[16:31]
    v_mfma_f32_4x4x4_16b_bf16 v[116:119], v[124:125], v[220:221], v[116:119]
    v_mfma_f32_4x4x4_16b_bf16 v[120:123], v[220:221], v[220:221], v[120:123]
    s_waitcnt vmcnt(2) lgkmcnt(0)
    s_barrier
    v_mfma_f32_32x32x16_bf16 v[16:31], v[48:51], v[224:227], v[16:31]
    ds_read_b64_tr_b16 v[232:233], v2 offset:8192
    ds_read_b64_tr_b16 v[234:235], v2 offset:9216
    ds_read_b128 v[56:59], v3 offset:26624
    ds_read_b64_tr_b16 v[236:237], v2 offset:12288
    ds_read_b64_tr_b16 v[238:239], v2 offset:13312
    ds_read_b128 v[60:63], v3 offset:27648
    v_mfma_f32_4x4x4_16b_bf16 v[116:119], v[124:125], v[224:225], v[116:119]
    v_mfma_f32_4x4x4_16b_bf16 v[120:123], v[224:225], v[224:225], v[120:123]
    v_mfma_f32_32x32x16_bf16 v[16:31], v[52:55], v[228:231], v[16:31]
    v_mfma_f32_4x4x4_16b_bf16 v[116:119], v[124:125], v[228:229], v[116:119]
    v_mfma_f32_4x4x4_16b_bf16 v[120:123], v[228:229], v[228:229], v[120:123]
    s_waitcnt vmcnt(1) lgkmcnt(0)
    s_barrier
    v_mfma_f32_32x32x16_bf16 v[16:31], v[56:59], v[232:235], v[16:31]
    ds_read_b64_tr_b16 v[240:241], v2 offset:16384
    ds_read_b64_tr_b16 v[242:243], v2 offset:17408
    ds_read_b128 v[48:51], v3 offset:28672
    ds_read_b64_tr_b16 v[244:245], v2 offset:20480
    ds_read_b64_tr_b16 v[246:247], v2 offset:21504
    ds_read_b128 v[52:55], v3 offset:29696
    v_mfma_f32_4x4x4_16b_bf16 v[116:119], v[124:125], v[232:233], v[116:119]
    v_mfma_f32_4x4x4_16b_bf16 v[120:123], v[232:233], v[232:233], v[120:123]
    v_mfma_f32_32x32x16_bf16 v[16:31], v[60:63], v[236:239], v[16:31]
    v_mfma_f32_4x4x4_16b_bf16 v[116:119], v[124:125], v[236:237], v[116:119]
    v_mfma_f32_4x4x4_16b_bf16 v[120:123], v[236:237], v[236:237], v[120:123]
    s_waitcnt vmcnt(0) lgkmcnt(0)
    s_barrier
    v_mfma_f32_32x32x16_bf16 v[16:31], v[48:51], v[240:243], v[16:31]
    ds_read_b64_tr_b16 v[248:249], v2 offset:24576
    ds_read_b64_tr_b16 v[250:251], v2 offset:25600
    ds_read_b128 v[56:59], v3 offset:30720
    ds_read_b64_tr_b16 v[252:253], v2 offset:28672
    ds_read_b64_tr_b16 v[254:255], v2 offset:29696
    ds_read_b128 v[60:63], v3 offset:31744
    v_mfma_f32_4x4x4_16b_bf16 v[116:119], v[124:125], v[240:241], v[116:119]
    v_mfma_f32_4x4x4_16b_bf16 v[120:123], v[240:241], v[240:241], v[120:123]
    v_mfma_f32_32x32x16_bf16 v[16:31], v[52:55], v[244:247], v[16:31]
    v_mfma_f32_4x4x4_16b_bf16 v[116:119], v[124:125], v[244:245], v[116:119]
    v_mfma_f32_4x4x4_16b_bf16 v[120:123], v[244:245], v[244:245], v[120:123]
    s_waitcnt lgkmcnt(0)
    v_mfma_f32_32x32x16_bf16 v[16:31], v[56:59], v[248:251], v[16:31]
    v_mfma_f32_4x4x4_16b_bf16 v[116:119], v[124:125], v[248:249], v[116:119]
    v_mfma_f32_4x4x4_16b_bf16 v[120:123], v[248:249], v[248:249], v[120:123]
    v_mfma_f32_32x32x16_bf16 v[16:31], v[60:63], v[252:255], v[16:31]
    v_mfma_f32_4x4x4_16b_bf16 v[116:119], v[124:125], v[252:253], v[116:119]
    v_mfma_f32_4x4x4_16b_bf16 v[120:123], v[252:253], v[252:253], v[120:123]
    v_add_u32 v3, 115712, v7
    s_setprio 1
    ds_read_b128 v[48:51], v3 offset:0
    ds_read_b128 v[52:55], v3 offset:1024
    ds_read_b128 v[56:59], v3 offset:2048
    ds_read_b128 v[60:63], v3 offset:3072
    ds_read_b128 v[64:67], v3 offset:4096
    ds_read_b128 v[68:71], v3 offset:5120
    ds_read_b128 v[72:75], v3 offset:6144
    s_waitcnt lgkmcnt(6)
    v_mfma_f32_32x32x16_bf16 v[32:47], v[48:51], v[128:131], 0
    v_and_b32 v14, 3, v0
    v_cmp_eq_u32 vcc, 1, v14
    s_nop 1
    v_cndmask_b32 v10, v120, v121, vcc
    v_cmp_eq_u32 vcc, 2, v14
    s_nop 1
    v_cndmask_b32 v10, v10, v122, vcc
    ds_read_b128 v[76:79], v3 offset:7168
    s_waitcnt lgkmcnt(6)
    v_mfma_f32_32x32x16_bf16 v[32:47], v[52:55], v[132:135], v[32:47]
    v_cmp_eq_u32 vcc, 3, v14
    s_nop 1
    v_cndmask_b32 v10, v10, v123, vcc
    v_mov_b32 v8, v116
    v_mov_b32 v9, v116
    v_mov_b32 v11, v10
    ds_read_b128 v[48:51], v3 offset:8192
    s_waitcnt lgkmcnt(6)
    v_mfma_f32_32x32x16_bf16 v[32:47], v[56:59], v[136:139], v[32:47]
    v_permlane32_swap_b32 v8, v9
    v_permlane32_swap_b32 v10, v11
    v_add_f32 v8, v8, v9
    v_add_f32 v9, v10, v11
    s_lshl_b32 s59, s3, 9
    ds_read_b128 v[52:55], v3 offset:9216
    s_waitcnt lgkmcnt(6)
    v_mfma_f32_32x32x16_bf16 v[32:47], v[60:63], v[140:143], v[32:47]
    s_add_u32 s59, s59, 151552
    v_lshl_add_u32 v14, v0, 3, s59
    ds_write_b64 v14, v[8:9]
    v_xor_b32 v14, 2048, v14
    ds_read_b128 v[56:59], v3 offset:10240
    s_waitcnt lgkmcnt(6)
    v_mfma_f32_32x32x16_bf16 v[32:47], v[64:67], v[144:147], v[32:47]
    ds_read_b128 v[60:63], v3 offset:11264
    s_waitcnt lgkmcnt(6)
    v_mfma_f32_32x32x16_bf16 v[32:47], v[68:71], v[148:151], v[32:47]
    s_waitcnt lgkmcnt(2)
    s_barrier
    ds_read_b64 v[10:11], v14
    ds_read_b128 v[64:67], v3 offset:12288
    s_waitcnt lgkmcnt(6)
    v_mfma_f32_32x32x16_bf16 v[32:47], v[72:75], v[152:155], v[32:47]
    s_add_u32 m0, s72, 0
    s_add_u32 s55, s71, 98304
    buffer_load_dwordx4 v7, s[4:7], s55 offen lds
    ds_read_b128 v[68:71], v3 offset:13312
    s_waitcnt lgkmcnt(6)
    v_mfma_f32_32x32x16_bf16 v[32:47], v[76:79], v[156:159], v[32:47]
    s_add_u32 m0, s72, 1024
    s_add_u32 s55, s71, 99328
    buffer_load_dwordx4 v7, s[4:7], s55 offen lds
    ds_read_b128 v[72:75], v3 offset:14336
    s_waitcnt lgkmcnt(6)
    v_mfma_f32_32x32x16_bf16 v[32:47], v[48:51], v[160:163], v[32:47]
    ds_read_b128 v[76:79], v3 offset:15360
    s_waitcnt lgkmcnt(6)
    v_mfma_f32_32x32x16_bf16 v[32:47], v[52:55], v[164:167], v[32:47]
    s_add_u32 m0, s72, 2048
    s_add_u32 s55, s71, 100352
    buffer_load_dwordx4 v7, s[4:7], s55 offen lds
    ds_read_b128 v[48:51], v3 offset:16384
    s_waitcnt lgkmcnt(6)
    v_mfma_f32_32x32x16_bf16 v[32:47], v[56:59], v[168:171], v[32:47]
    s_add_u32 m0, s72, 3072
    s_add_u32 s55, s71, 101376
    buffer_load_dwordx4 v7, s[4:7], s55 offen lds
    ds_read_b128 v[52:55], v3 offset:17408
    s_waitcnt lgkmcnt(6)
    v_mfma_f32_32x32x16_bf16 v[32:47], v[60:63], v[172:175], v[32:47]
    ds_read_b128 v[56:59], v3 offset:18432
    s_waitcnt lgkmcnt(6)
    v_mfma_f32_32x32x16_bf16 v[32:47], v[64:67], v[176:179], v[32:47]
    s_add_u32 m0, s72, 4096
    s_add_u32 s55, s71, 102400
    buffer_load_dwordx4 v7, s[4:7], s55 offen lds
    v_add_f32 v8, v8, v10
    v_add_f32 v10, v9, v11
    ds_read_b128 v[60:63], v3 offset:19456
    s_waitcnt lgkmcnt(6)
    v_mfma_f32_32x32x16_bf16 v[32:47], v[68:71], v[180:183], v[32:47]
    v_mul_f32 v8, 0x3b000000, v8
    v_mul_f32 v10, 0x3b000000, v10
    ds_read_b128 v[64:67], v3 offset:20480
    s_waitcnt lgkmcnt(6)
    v_mfma_f32_32x32x16_bf16 v[32:47], v[72:75], v[184:187], v[32:47]
    s_add_u32 m0, s72, 5120
    s_add_u32 s55, s71, 103424
    buffer_load_dwordx4 v7, s[4:7], s55 offen lds
    v_fma_f32 v10, -v8, v8, v10
    v_max_f32 v10, 0, v10
    ds_read_b128 v[68:71], v3 offset:21504
    s_waitcnt lgkmcnt(6)
    v_mfma_f32_32x32x16_bf16 v[32:47], v[76:79], v[188:191], v[32:47]
    s_add_u32 m0, s72, 6144
    s_add_u32 s55, s71, 104448
    buffer_load_dwordx4 v7, s[4:7], s55 offen lds
    v_cvt_pk_bf16_f32 v14, v10, v10
    v_lshlrev_b32 v14, 16, v14
    ds_read_b128 v[72:75], v3 offset:22528
    s_waitcnt lgkmcnt(6)
    v_mfma_f32_32x32x16_bf16 v[32:47], v[48:51], v[192:195], v[32:47]
    v_add_f32 v14, 0x3727c5ac, v14
    v_cvt_pk_bf16_f32 v14, v14, v14
    ds_read_b128 v[76:79], v3 offset:23552
    s_waitcnt lgkmcnt(6)
    v_mfma_f32_32x32x16_bf16 v[32:47], v[52:55], v[196:199], v[32:47]
    s_add_u32 m0, s72, 7168
    s_add_u32 s55, s71, 105472
    buffer_load_dwordx4 v7, s[4:7], s55 offen lds
    v_lshlrev_b32 v14, 16, v14
    v_sqrt_f32 v14, v14
    ds_read_b128 v[48:51], v3 offset:24576
    s_waitcnt lgkmcnt(6)
    v_mfma_f32_32x32x16_bf16 v[32:47], v[56:59], v[200:203], v[32:47]
    s_add_u32 m0, s72, 50176
    s_add_u32 s55, s71, 131072
    buffer_load_dwordx4 v7, s[4:7], s55 offen lds
    v_cvt_pk_bf16_f32 v15, v14, v14
    v_lshlrev_b32 v10, 16, v15
    ds_read_b128 v[52:55], v3 offset:25600
    s_waitcnt lgkmcnt(6)
    v_mfma_f32_32x32x16_bf16 v[32:47], v[60:63], v[204:207], v[32:47]
    v_cvt_pk_bf16_f32 v14, v8, v8
    v_rcp_f32 v5, v10
    ds_read_b128 v[56:59], v3 offset:26624
    s_waitcnt lgkmcnt(6)
    v_mfma_f32_32x32x16_bf16 v[32:47], v[64:67], v[208:211], v[32:47]
    s_add_u32 m0, s72, 51200
    s_add_u32 s55, s71, 132096
    buffer_load_dwordx4 v7, s[4:7], s55 offen lds
    v_lshlrev_b32 v14, 16, v14
    v_sub_f32 v4, 0, v14
    ds_read_b128 v[60:63], v3 offset:27648
    s_waitcnt lgkmcnt(6)
    v_mfma_f32_32x32x16_bf16 v[32:47], v[68:71], v[212:215], v[32:47]
    v_mul_f32 v114, v10, v10
    v_mul_f32 v6, 0xc0135761, v5
    ds_read_b128 v[64:67], v3 offset:28672
    s_waitcnt lgkmcnt(6)
    v_mfma_f32_32x32x16_bf16 v[32:47], v[72:75], v[216:219], v[32:47]
    s_add_u32 m0, s72, 52224
    s_add_u32 s55, s71, 133120
    buffer_load_dwordx4 v7, s[4:7], s55 offen lds
    v_mul_f32 v113, v5, v5
    v_mul_f32 v113, v113, v5
    ds_read_b128 v[68:71], v3 offset:29696
    s_waitcnt lgkmcnt(6)
    v_mfma_f32_32x32x16_bf16 v[32:47], v[76:79], v[220:223], v[32:47]
    s_add_u32 m0, s72, 53248
    s_add_u32 s55, s71, 134144
    buffer_load_dwordx4 v7, s[4:7], s55 offen lds
    v_mul_f32 v113, 0xbdd2d3e8, v113
    ds_read_b128 v[72:75], v3 offset:30720
    s_waitcnt lgkmcnt(6)
    v_mfma_f32_32x32x16_bf16 v[32:47], v[48:51], v[224:227], v[32:47]
    ds_read_b128 v[76:79], v3 offset:31744
    s_waitcnt lgkmcnt(6)
    v_mfma_f32_32x32x16_bf16 v[32:47], v[52:55], v[228:231], v[32:47]
    s_add_u32 m0, s72, 54272
    s_add_u32 s55, s71, 135168
    buffer_load_dwordx4 v7, s[4:7], s55 offen lds
    s_waitcnt lgkmcnt(5)
    v_mfma_f32_32x32x16_bf16 v[32:47], v[56:59], v[232:235], v[32:47]
    s_add_u32 m0, s72, 55296
    s_add_u32 s55, s71, 136192
    buffer_load_dwordx4 v7, s[4:7], s55 offen lds
    s_waitcnt lgkmcnt(4)
    v_mfma_f32_32x32x16_bf16 v[32:47], v[60:63], v[236:239], v[32:47]
    s_waitcnt lgkmcnt(3)
    v_mfma_f32_32x32x16_bf16 v[32:47], v[64:67], v[240:243], v[32:47]
    s_add_u32 m0, s72, 56320
    s_add_u32 s55, s71, 137216
    buffer_load_dwordx4 v7, s[4:7], s55 offen lds
    s_waitcnt lgkmcnt(2)
    v_mfma_f32_32x32x16_bf16 v[32:47], v[68:71], v[244:247], v[32:47]
    s_waitcnt lgkmcnt(1)
    v_mfma_f32_32x32x16_bf16 v[32:47], v[72:75], v[248:251], v[32:47]
    s_add_u32 m0, s72, 57344
    s_add_u32 s55, s71, 138240
    buffer_load_dwordx4 v7, s[4:7], s55 offen lds
    s_waitcnt lgkmcnt(0)
    v_mfma_f32_32x32x16_bf16 v[32:47], v[76:79], v[252:255], v[32:47]
    s_setprio 0
    s_waitcnt vmcnt(8)
    s_barrier
    ds_read_b128 v[64:67], v12 offset:0
    ds_read_b128 v[68:71], v12 offset:32
    ds_read_b128 v[72:75], v12 offset:64
    ds_read_b128 v[76:79], v12 offset:96
    s_waitcnt lgkmcnt(3)
    v_fmac_f32 v16, v4, v64
    v_fmac_f32 v17, v4, v65
    v_fmac_f32 v18, v4, v66
    v_fmac_f32 v19, v4, v67
    v_mul_f32 v80, v16, v16
    v_mul_f32 v81, v17, v17
    v_mul_f32 v82, v18, v18
    v_mul_f32 v83, v19, v19
    s_waitcnt lgkmcnt(2)
    v_fmac_f32 v20, v4, v68
    v_fmac_f32 v21, v4, v69
    v_fmac_f32 v22, v4, v70
    v_fmac_f32 v23, v4, v71
    v_mul_f32 v84, v20, v20
    v_mul_f32 v85, v21, v21
    v_mul_f32 v86, v22, v22
    v_mul_f32 v87, v23, v23
    s_waitcnt lgkmcnt(1)
    v_fmac_f32 v24, v4, v72
    v_fmac_f32 v25, v4, v73
    v_fmac_f32 v26, v4, v74
    v_fmac_f32 v27, v4, v75
    s_waitcnt lgkmcnt(0)
    v_fmac_f32 v28, v4, v76
    v_fmac_f32 v29, v4, v77
    v_fmac_f32 v30, v4, v78
    v_fmac_f32 v31, v4, v79
    v_fma_f32 v80, v80, v113, v6
    v_fma_f32 v81, v81, v113, v6
    v_fma_f32 v82, v82, v113, v6
    v_fma_f32 v83, v83, v113, v6
    v_fma_f32 v84, v84, v113, v6
    v_fma_f32 v85, v85, v113, v6
    v_fma_f32 v86, v86, v113, v6
    v_fma_f32 v87, v87, v113, v6
    v_mul_f32 v80, v80, v16
    v_mul_f32 v81, v81, v17
    v_mul_f32 v82, v82, v18
    v_mul_f32 v83, v83, v19
    v_mul_f32 v84, v84, v20
    v_mul_f32 v85, v85, v21
    v_mul_f32 v86, v86, v22
    v_mul_f32 v87, v87, v23
    v_exp_f32 v80, v80
    v_mul_f32 v16, v16, v24
    v_exp_f32 v81, v81
    v_mul_f32 v17, v17, v25
    v_exp_f32 v82, v82
    v_mul_f32 v18, v18, v26
    v_exp_f32 v83, v83
    v_mul_f32 v19, v19, v27
    v_exp_f32 v84, v84
    v_mul_f32 v20, v20, v28
    v_exp_f32 v85, v85
    v_mul_f32 v21, v21, v29
    v_exp_f32 v86, v86
    v_mul_f32 v22, v22, v30
    v_exp_f32 v87, v87
    v_mul_f32 v23, v23, v31
    v_fma_f32 v80, v80, v114, v114
    v_fma_f32 v81, v81, v114, v114
    v_fma_f32 v82, v82, v114, v114
    v_fma_f32 v83, v83, v114, v114
    v_fma_f32 v84, v84, v114, v114
    v_fma_f32 v85, v85, v114, v114
    v_fma_f32 v86, v86, v114, v114
    v_fma_f32 v87, v87, v114, v114
    v_rcp_f32 v80, v80
    v_rcp_f32 v81, v81
    v_rcp_f32 v82, v82
    v_rcp_f32 v83, v83
    v_rcp_f32 v84, v84
    v_rcp_f32 v85, v85
    v_rcp_f32 v86, v86
    v_rcp_f32 v87, v87
    v_mul_f32 v16, v16, v80
    v_mul_f32 v17, v17, v81
    v_cvt_pk_bf16_f32 v88, v16, v17
    v_mul_f32 v18, v18, v82
    v_mul_f32 v19, v19, v83
    v_cvt_pk_bf16_f32 v89, v18, v19
    v_mul_f32 v20, v20, v84
    v_mul_f32 v21, v21, v85
    v_cvt_pk_bf16_f32 v90, v20, v21
    v_mul_f32 v22, v22, v86
    v_mul_f32 v23, v23, v87
    v_cvt_pk_bf16_f32 v91, v22, v23
    v_permlane32_swap_b32 v88, v90
    s_nop 0
    v_permlane32_swap_b32 v89, v91
    s_add_u32 s58, s78, 0
    buffer_store_dwordx4 v[88:91], v7, s[4:7], s58 offen sc1
    ds_read_b128 v[64:67], v12 offset:256
    ds_read_b128 v[68:71], v12 offset:288
    ds_read_b128 v[72:75], v12 offset:320
    ds_read_b128 v[76:79], v12 offset:352
    s_waitcnt lgkmcnt(3)
    v_fmac_f32 v32, v4, v64
    v_fmac_f32 v33, v4, v65
    v_fmac_f32 v34, v4, v66
    v_fmac_f32 v35, v4, v67
    v_mul_f32 v80, v32, v32
    v_mul_f32 v81, v33, v33
    v_mul_f32 v82, v34, v34
    v_mul_f32 v83, v35, v35
    s_waitcnt lgkmcnt(2)
    v_fmac_f32 v36, v4, v68
    v_fmac_f32 v37, v4, v69
    v_fmac_f32 v38, v4, v70
    v_fmac_f32 v39, v4, v71
    v_mul_f32 v84, v36, v36
    v_mul_f32 v85, v37, v37
    v_mul_f32 v86, v38, v38
    v_mul_f32 v87, v39, v39
    s_waitcnt lgkmcnt(1)
    v_fmac_f32 v40, v4, v72
    v_fmac_f32 v41, v4, v73
    v_fmac_f32 v42, v4, v74
    v_fmac_f32 v43, v4, v75
    s_waitcnt lgkmcnt(0)
    v_fmac_f32 v44, v4, v76
    v_fmac_f32 v45, v4, v77
    v_fmac_f32 v46, v4, v78
    v_fmac_f32 v47, v4, v79
    v_fma_f32 v80, v80, v113, v6
    v_fma_f32 v81, v81, v113, v6
    v_fma_f32 v82, v82, v113, v6
    v_fma_f32 v83, v83, v113, v6
    v_fma_f32 v84, v84, v113, v6
    v_fma_f32 v85, v85, v113, v6
    v_fma_f32 v86, v86, v113, v6
    v_fma_f32 v87, v87, v113, v6
    v_mul_f32 v80, v80, v32
    v_mul_f32 v81, v81, v33
    v_mul_f32 v82, v82, v34
    v_mul_f32 v83, v83, v35
    v_mul_f32 v84, v84, v36
    v_mul_f32 v85, v85, v37
    v_mul_f32 v86, v86, v38
    v_mul_f32 v87, v87, v39
    v_exp_f32 v80, v80
    v_mul_f32 v32, v32, v40
    v_exp_f32 v81, v81
    v_mul_f32 v33, v33, v41
    v_exp_f32 v82, v82
    v_mul_f32 v34, v34, v42
    v_exp_f32 v83, v83
    v_mul_f32 v35, v35, v43
    v_exp_f32 v84, v84
    v_mul_f32 v36, v36, v44
    v_exp_f32 v85, v85
    v_mul_f32 v37, v37, v45
    v_exp_f32 v86, v86
    v_mul_f32 v38, v38, v46
    v_exp_f32 v87, v87
    v_mul_f32 v39, v39, v47
    v_fma_f32 v80, v80, v114, v114
    v_fma_f32 v81, v81, v114, v114
    v_fma_f32 v82, v82, v114, v114
    v_fma_f32 v83, v83, v114, v114
    v_fma_f32 v84, v84, v114, v114
    v_fma_f32 v85, v85, v114, v114
    v_fma_f32 v86, v86, v114, v114
    v_fma_f32 v87, v87, v114, v114
    v_rcp_f32 v80, v80
    v_rcp_f32 v81, v81
    v_rcp_f32 v82, v82
    v_rcp_f32 v83, v83
    v_rcp_f32 v84, v84
    v_rcp_f32 v85, v85
    v_rcp_f32 v86, v86
    v_rcp_f32 v87, v87
    v_mul_f32 v32, v32, v80
    v_mul_f32 v33, v33, v81
    v_cvt_pk_bf16_f32 v88, v32, v33
    v_mul_f32 v34, v34, v82
    v_mul_f32 v35, v35, v83
    v_cvt_pk_bf16_f32 v89, v34, v35
    v_mul_f32 v36, v36, v84
    v_mul_f32 v37, v37, v85
    v_cvt_pk_bf16_f32 v90, v36, v37
    v_mul_f32 v38, v38, v86
    v_mul_f32 v39, v39, v87
    v_cvt_pk_bf16_f32 v91, v38, v39
    v_permlane32_swap_b32 v88, v90
    s_nop 0
    v_permlane32_swap_b32 v89, v91
    s_add_u32 s58, s78, 2048
    buffer_store_dwordx4 v[88:91], v7, s[4:7], s58 offen sc1
    s_waitcnt vmcnt(2)
    s_barrier
    v_add_u32 v3, 50176, v7
    s_setprio 1
    ds_read_b128 v[48:51], v3 offset:0
    ds_read_b128 v[52:55], v3 offset:1024
    ds_read_b128 v[56:59], v3 offset:2048
    ds_read_b128 v[60:63], v3 offset:3072
    ds_read_b128 v[64:67], v3 offset:4096
    ds_read_b128 v[68:71], v3 offset:5120
    ds_read_b128 v[72:75], v3 offset:6144
    s_waitcnt lgkmcnt(6)
    v_mfma_f32_32x32x16_bf16 v[16:31], v[48:51], v[128:131], 0
    ds_read_b128 v[76:79], v3 offset:7168
    s_waitcnt lgkmcnt(6)
    v_mfma_f32_32x32x16_bf16 v[16:31], v[52:55], v[132:135], v[16:31]
    s_add_u32 m0, s74, 0
    s_add_u32 s55, s73, 0
    buffer_load_dwordx4 v112, s[8:11], s55 offen lds
    ds_read_b128 v[48:51], v3 offset:8192
    s_waitcnt lgkmcnt(6)
    v_mfma_f32_32x32x16_bf16 v[16:31], v[56:59], v[136:139], v[16:31]
    ds_read_b128 v[52:55], v3 offset:9216
    s_waitcnt lgkmcnt(6)
    v_mfma_f32_32x32x16_bf16 v[16:31], v[60:63], v[140:143], v[16:31]
    s_add_u32 m0, s74, 1024
    s_add_u32 s55, s73, 8192
    buffer_load_dwordx4 v112, s[8:11], s55 offen lds
    ds_read_b128 v[56:59], v3 offset:10240
    s_waitcnt lgkmcnt(6)
    v_mfma_f32_32x32x16_bf16 v[16:31], v[64:67], v[144:147], v[16:31]
    ds_read_b128 v[60:63], v3 offset:11264
    s_waitcnt lgkmcnt(6)
    v_mfma_f32_32x32x16_bf16 v[16:31], v[68:71], v[148:151], v[16:31]
    ds_read_b128 v[64:67], v3 offset:12288
    s_waitcnt lgkmcnt(6)
    v_mfma_f32_32x32x16_bf16 v[16:31], v[72:75], v[152:155], v[16:31]
    s_add_u32 m0, s74, 2048
    s_add_u32 s55, s73, 16384
    buffer_load_dwordx4 v112, s[8:11], s55 offen lds
    ds_read_b128 v[68:71], v3 offset:13312
    s_waitcnt lgkmcnt(6)
    v_mfma_f32_32x32x16_bf16 v[16:31], v[76:79], v[156:159], v[16:31]
    ds_read_b128 v[72:75], v3 offset:14336
    s_waitcnt lgkmcnt(6)
    v_mfma_f32_32x32x16_bf16 v[16:31], v[48:51], v[160:163], v[16:31]
    s_add_u32 m0, s74, 3072
    s_add_u32 s55, s73, 24576
    buffer_load_dwordx4 v112, s[8:11], s55 offen lds
    ds_read_b128 v[76:79], v3 offset:15360
    s_waitcnt lgkmcnt(6)
    v_mfma_f32_32x32x16_bf16 v[16:31], v[52:55], v[164:167], v[16:31]
    ds_read_b128 v[48:51], v3 offset:16384
    s_waitcnt lgkmcnt(6)
    v_mfma_f32_32x32x16_bf16 v[16:31], v[56:59], v[168:171], v[16:31]
    ds_read_b128 v[52:55], v3 offset:17408
    s_waitcnt lgkmcnt(6)
    v_mfma_f32_32x32x16_bf16 v[16:31], v[60:63], v[172:175], v[16:31]
    s_add_u32 m0, s74, 16384
    s_add_u32 s55, s73, 32768
    buffer_load_dwordx4 v112, s[8:11], s55 offen lds
    ds_read_b128 v[56:59], v3 offset:18432
    s_waitcnt lgkmcnt(6)
    v_mfma_f32_32x32x16_bf16 v[16:31], v[64:67], v[176:179], v[16:31]
    ds_read_b128 v[60:63], v3 offset:19456
    s_waitcnt lgkmcnt(6)
    v_mfma_f32_32x32x16_bf16 v[16:31], v[68:71], v[180:183], v[16:31]
    ds_read_b128 v[64:67], v3 offset:20480
    s_waitcnt lgkmcnt(6)
    v_mfma_f32_32x32x16_bf16 v[16:31], v[72:75], v[184:187], v[16:31]
    s_add_u32 m0, s74, 17408
    s_add_u32 s55, s73, 40960
    buffer_load_dwordx4 v112, s[8:11], s55 offen lds
    ds_read_b128 v[68:71], v3 offset:21504
    s_waitcnt lgkmcnt(6)
    v_mfma_f32_32x32x16_bf16 v[16:31], v[76:79], v[188:191], v[16:31]
    ds_read_b128 v[72:75], v3 offset:22528
    s_waitcnt lgkmcnt(6)
    v_mfma_f32_32x32x16_bf16 v[16:31], v[48:51], v[192:195], v[16:31]
    s_add_u32 m0, s74, 18432
    s_add_u32 s55, s73, 458752
    buffer_load_dwordx4 v112, s[8:11], s55 offen lds
    ds_read_b128 v[76:79], v3 offset:23552
    s_waitcnt lgkmcnt(6)
    v_mfma_f32_32x32x16_bf16 v[16:31], v[52:55], v[196:199], v[16:31]
    ds_read_b128 v[48:51], v3 offset:24576
    s_waitcnt lgkmcnt(6)
    v_mfma_f32_32x32x16_bf16 v[16:31], v[56:59], v[200:203], v[16:31]
    ds_read_b128 v[52:55], v3 offset:25600
    s_waitcnt lgkmcnt(6)
    v_mfma_f32_32x32x16_bf16 v[16:31], v[60:63], v[204:207], v[16:31]
    s_add_u32 m0, s74, 19456
    s_add_u32 s55, s73, 466944
    buffer_load_dwordx4 v112, s[8:11], s55 offen lds
    ds_read_b128 v[56:59], v3 offset:26624
    s_waitcnt lgkmcnt(6)
    v_mfma_f32_32x32x16_bf16 v[16:31], v[64:67], v[208:211], v[16:31]
    ds_read_b128 v[60:63], v3 offset:27648
    s_waitcnt lgkmcnt(6)
    v_mfma_f32_32x32x16_bf16 v[16:31], v[68:71], v[212:215], v[16:31]
    ds_read_b128 v[64:67], v3 offset:28672
    s_waitcnt lgkmcnt(6)
    v_mfma_f32_32x32x16_bf16 v[16:31], v[72:75], v[216:219], v[16:31]
    s_add_u32 m0, s74, 32768
    s_add_u32 s55, s73, 475136
    buffer_load_dwordx4 v112, s[8:11], s55 offen lds
    ds_read_b128 v[68:71], v3 offset:29696
    s_waitcnt lgkmcnt(6)
    v_mfma_f32_32x32x16_bf16 v[16:31], v[76:79], v[220:223], v[16:31]
    ds_read_b128 v[72:75], v3 offset:30720
    s_waitcnt lgkmcnt(6)
    v_mfma_f32_32x32x16_bf16 v[16:31], v[48:51], v[224:227], v[16:31]
    s_add_u32 m0, s74, 33792
    s_add_u32 s55, s73, 483328
    buffer_load_dwordx4 v112, s[8:11], s55 offen lds
    ds_read_b128 v[76:79], v3 offset:31744
    s_waitcnt lgkmcnt(6)
    v_mfma_f32_32x32x16_bf16 v[16:31], v[52:55], v[228:231], v[16:31]
    s_waitcnt lgkmcnt(5)
    v_mfma_f32_32x32x16_bf16 v[16:31], v[56:59], v[232:235], v[16:31]
    s_waitcnt lgkmcnt(4)
    v_mfma_f32_32x32x16_bf16 v[16:31], v[60:63], v[236:239], v[16:31]
    s_add_u32 m0, s74, 34816
    s_add_u32 s55, s73, 491520
    buffer_load_dwordx4 v112, s[8:11], s55 offen lds
    s_waitcnt lgkmcnt(3)
    v_mfma_f32_32x32x16_bf16 v[16:31], v[64:67], v[240:243], v[16:31]
    s_waitcnt lgkmcnt(2)
    v_mfma_f32_32x32x16_bf16 v[16:31], v[68:71], v[244:247], v[16:31]
    s_waitcnt lgkmcnt(1)
    v_mfma_f32_32x32x16_bf16 v[16:31], v[72:75], v[248:251], v[16:31]
    s_add_u32 m0, s74, 35840
    s_add_u32 s55, s73, 499712
    buffer_load_dwordx4 v112, s[8:11], s55 offen lds
    s_waitcnt lgkmcnt(0)
    v_mfma_f32_32x32x16_bf16 v[16:31], v[76:79], v[252:255], v[16:31]
    s_setprio 0
    s_waitcnt vmcnt(12)
    s_barrier
    s_cmp_eq_u32 s3, 0
    s_cbranch_scc0 L_arr3a_40
    s_lshl_b32 s56, s51, 8
    s_add_u32 s56, s56, 274432
    v_mov_b32 v14, 1
    v_mov_b32 v15, 0
    s_mov_b64 s[90:91], exec
    s_mov_b64 exec, 1
    buffer_atomic_add v14, v15, s[4:7], s56 offen
    s_mov_b64 exec, s[90:91]
L_arr3a_40:
    ds_read_b128 v[64:67], v12 offset:512
    ds_read_b128 v[68:71], v12 offset:544
    ds_read_b128 v[72:75], v12 offset:576
    ds_read_b128 v[76:79], v12 offset:608
    s_waitcnt lgkmcnt(3)
    s_nop 1
    v_fmac_f32 v16, v4, v64
    v_fmac_f32 v17, v4, v65
    v_fmac_f32 v18, v4, v66
    v_fmac_f32 v19, v4, v67
    v_mul_f32 v80, v16, v16
    v_mul_f32 v81, v17, v17
    v_mul_f32 v82, v18, v18
    v_mul_f32 v83, v19, v19
    s_waitcnt lgkmcnt(2)
    v_fmac_f32 v20, v4, v68
    v_fmac_f32 v21, v4, v69
    v_fmac_f32 v22, v4, v70
    v_fmac_f32 v23, v4, v71
    v_mul_f32 v84, v20, v20
    v_mul_f32 v85, v21, v21
    v_mul_f32 v86, v22, v22
    v_mul_f32 v87, v23, v23
    s_waitcnt lgkmcnt(1)
    v_fmac_f32 v24, v4, v72
    v_fmac_f32 v25, v4, v73
    v_fmac_f32 v26, v4, v74
    v_fmac_f32 v27, v4, v75
    s_waitcnt lgkmcnt(0)
    v_fmac_f32 v28, v4, v76
    v_fmac_f32 v29, v4, v77
    v_fmac_f32 v30, v4, v78
    v_fmac_f32 v31, v4, v79
    v_fma_f32 v80, v80, v113, v6
    v_fma_f32 v81, v81, v113, v6
    v_fma_f32 v82, v82, v113, v6
    v_fma_f32 v83, v83, v113, v6
    v_fma_f32 v84, v84, v113, v6
    v_fma_f32 v85, v85, v113, v6
    v_fma_f32 v86, v86, v113, v6
    v_fma_f32 v87, v87, v113, v6
    v_mul_f32 v80, v80, v16
    v_mul_f32 v81, v81, v17
    v_mul_f32 v82, v82, v18
    v_mul_f32 v83, v83, v19
    v_mul_f32 v84, v84, v20
    v_mul_f32 v85, v85, v21
    v_mul_f32 v86, v86, v22
    v_mul_f32 v87, v87, v23
    v_exp_f32 v80, v80
    v_mul_f32 v16, v16, v24
    v_exp_f32 v81, v81
    v_mul_f32 v17, v17, v25
    v_exp_f32 v82, v82
    v_mul_f32 v18, v18, v26
    v_exp_f32 v83, v83
    v_mul_f32 v19, v19, v27
    v_exp_f32 v84, v84
    v_mul_f32 v20, v20, v28
    v_exp_f32 v85, v85
    v_mul_f32 v21, v21, v29
    v_exp_f32 v86, v86
    v_mul_f32 v22, v22, v30
    v_exp_f32 v87, v87
    v_mul_f32 v23, v23, v31
    v_fma_f32 v80, v80, v114, v114
    v_fma_f32 v81, v81, v114, v114
    v_fma_f32 v82, v82, v114, v114
    v_fma_f32 v83, v83, v114, v114
    v_fma_f32 v84, v84, v114, v114
    v_fma_f32 v85, v85, v114, v114
    v_fma_f32 v86, v86, v114, v114
    v_fma_f32 v87, v87, v114, v114
    v_rcp_f32 v80, v80
    v_rcp_f32 v81, v81
    v_rcp_f32 v82, v82
    v_rcp_f32 v83, v83
    v_rcp_f32 v84, v84
    v_rcp_f32 v85, v85
    v_rcp_f32 v86, v86
    v_rcp_f32 v87, v87
    v_mul_f32 v16, v16, v80
    v_mul_f32 v17, v17, v81
    v_cvt_pk_bf16_f32 v88, v16, v17
    v_mul_f32 v18, v18, v82
    v_mul_f32 v19, v19, v83
    v_cvt_pk_bf16_f32 v89, v18, v19
    v_mul_f32 v20, v20, v84
    v_mul_f32 v21, v21, v85
    v_cvt_pk_bf16_f32 v90, v20, v21
    v_mul_f32 v22, v22, v86
    v_mul_f32 v23, v23, v87
    v_cvt_pk_bf16_f32 v91, v22, v23
    v_permlane32_swap_b32 v88, v90
    s_nop 0
    v_permlane32_swap_b32 v89, v91
    s_add_u32 s58, s78, 4096
    buffer_store_dwordx4 v[88:91], v7, s[4:7], s58 offen sc1
    s_and_b32 s16, s3, 1
    s_lshr_b32 s17, s3, 1
    s_mul_i32 s19, s17, 114688
    s_lshl_b32 s18, s53, 1
    s_add_u32 s18, s18, s16
    s_mul_i32 s18, s18, 112
    s_mul_i32 s55, s17, 7
    s_add_u32 s18, s18, s55
    s_lshl_b32 s18, s18, 10
    s_add_u32 s18, s18, 7340032
    v_and_b32 v14, 15, v0
    v_lshrrev_b32 v14, 2, v14
    v_lshrrev_b32 v15, 5, v0
    v_lshl_add_u32 v15, v15, 3, v14
    s_lshl_b32 s55, s17, 5
    v_add_u32 v15, s55, v15
    v_lshlrev_b32 v2, 7, v15
    v_bfe_u32 v14, v14, 1, 1
    v_lshlrev_b32 v14, 2, v14
    v_bfe_u32 v15, v0, 4, 1
    v_lshlrev_b32 v15, 1, v15
    v_bfe_u32 v8, v0, 1, 1
    v_add_u32 v15, v15, v8
    v_xor_b32 v9, v15, v14
    v_or_b32 v15, 4, v15
    v_xor_b32 v10, v15, v14
    v_and_b32 v8, 1, v0
    v_lshlrev_b32 v8, 3, v8
    v_add_u32 v2, v2, v8
    v_lshl_add_u32 v11, v10, 4, v2
    v_lshl_add_u32 v2, v9, 4, v2
    v_lshrrev_b32 v14, 3, v0
    v_and_b32 v15, 7, v0
    v_lshlrev_b32 v15, 4, v15
    v_lshl_add_u32 v13, v14, 12, v15
    s_barrier
    v_add_u32 v3, 115712, v7
    s_setprio 1
    ds_read_b128 v[48:51], v3 offset:0
    ds_read_b128 v[52:55], v3 offset:1024
    ds_read_b128 v[56:59], v3 offset:2048
    ds_read_b128 v[60:63], v3 offset:3072
    ds_read_b128 v[64:67], v3 offset:4096
    ds_read_b128 v[68:71], v3 offset:5120
    ds_read_b128 v[72:75], v3 offset:6144
    s_waitcnt lgkmcnt(6)
    v_mfma_f32_32x32x16_bf16 v[16:31], v[48:51], v[128:131], 0
    ds_read_b128 v[76:79], v3 offset:7168
    s_waitcnt lgkmcnt(6)
    v_mfma_f32_32x32x16_bf16 v[16:31], v[52:55], v[132:135], v[16:31]
    s_add_u32 m0, s74, 81920
    s_add_u32 s55, s73, 1392640
    buffer_load_dwordx4 v112, s[8:11], s55 offen lds
    ds_read_b128 v[48:51], v3 offset:8192
    s_waitcnt lgkmcnt(6)
    v_mfma_f32_32x32x16_bf16 v[16:31], v[56:59], v[136:139], v[16:31]
    ds_read_b128 v[52:55], v3 offset:9216
    s_waitcnt lgkmcnt(6)
    v_mfma_f32_32x32x16_bf16 v[16:31], v[60:63], v[140:143], v[16:31]
    ds_read_b128 v[56:59], v3 offset:10240
    s_waitcnt lgkmcnt(6)
    v_mfma_f32_32x32x16_bf16 v[16:31], v[64:67], v[144:147], v[16:31]
    ds_read_b128 v[60:63], v3 offset:11264
    s_waitcnt lgkmcnt(6)
    v_mfma_f32_32x32x16_bf16 v[16:31], v[68:71], v[148:151], v[16:31]
    s_add_u32 m0, s74, 82944
    s_add_u32 s55, s73, 1400832
    buffer_load_dwordx4 v112, s[8:11], s55 offen lds
    ds_read_b128 v[64:67], v3 offset:12288
    s_waitcnt lgkmcnt(6)
    v_mfma_f32_32x32x16_bf16 v[16:31], v[72:75], v[152:155], v[16:31]
    ds_read_b128 v[68:71], v3 offset:13312
    s_waitcnt lgkmcnt(6)
    v_mfma_f32_32x32x16_bf16 v[16:31], v[76:79], v[156:159], v[16:31]
    ds_read_b128 v[72:75], v3 offset:14336
    s_waitcnt lgkmcnt(6)
    v_mfma_f32_32x32x16_bf16 v[16:31], v[48:51], v[160:163], v[16:31]
    ds_read_b128 v[76:79], v3 offset:15360
    s_waitcnt lgkmcnt(6)
    v_mfma_f32_32x32x16_bf16 v[16:31], v[52:55], v[164:167], v[16:31]
    s_add_u32 m0, s74, 83968
    s_add_u32 s55, s73, 1409024
    buffer_load_dwordx4 v112, s[8:11], s55 offen lds
    ds_read_b128 v[48:51], v3 offset:16384
    s_waitcnt lgkmcnt(6)
    v_mfma_f32_32x32x16_bf16 v[16:31], v[56:59], v[168:171], v[16:31]
    ds_read_b128 v[52:55], v3 offset:17408
    s_waitcnt lgkmcnt(6)
    v_mfma_f32_32x32x16_bf16 v[16:31], v[60:63], v[172:175], v[16:31]
    ds_read_b128 v[56:59], v3 offset:18432
    s_waitcnt lgkmcnt(6)
    v_mfma_f32_32x32x16_bf16 v[16:31], v[64:67], v[176:179], v[16:31]
    ds_read_b128 v[60:63], v3 offset:19456
    s_waitcnt lgkmcnt(6)
    v_mfma_f32_32x32x16_bf16 v[16:31], v[68:71], v[180:183], v[16:31]
    s_add_u32 m0, s74, 84992
    s_add_u32 s55, s73, 1417216
    buffer_load_dwordx4 v112, s[8:11], s55 offen lds
    ds_read_b128 v[64:67], v3 offset:20480
    s_waitcnt lgkmcnt(6)
    v_mfma_f32_32x32x16_bf16 v[16:31], v[72:75], v[184:187], v[16:31]
    ds_read_b128 v[68:71], v3 offset:21504
    s_waitcnt lgkmcnt(6)
    v_mfma_f32_32x32x16_bf16 v[16:31], v[76:79], v[188:191], v[16:31]
    ds_read_b128 v[72:75], v3 offset:22528
    s_waitcnt lgkmcnt(6)
    v_mfma_f32_32x32x16_bf16 v[16:31], v[48:51], v[192:195], v[16:31]
    ds_read_b128 v[76:79], v3 offset:23552
    s_waitcnt lgkmcnt(6)
    v_mfma_f32_32x32x16_bf16 v[16:31], v[52:55], v[196:199], v[16:31]
    s_add_u32 m0, s74, 98304
    s_add_u32 s55, s73, 49152
    buffer_load_dwordx4 v112, s[8:11], s55 offen lds
    ds_read_b128 v[48:51], v3 offset:24576
    s_waitcnt lgkmcnt(6)
    v_mfma_f32_32x32x16_bf16 v[16:31], v[56:59], v[200:203], v[16:31]
    ds_read_b128 v[52:55], v3 offset:25600
    s_waitcnt lgkmcnt(6)
    v_mfma_f32_32x32x16_bf16 v[16:31], v[60:63], v[204:207], v[16:31]
    ds_read_b128 v[56:59], v3 offset:26624
    s_waitcnt lgkmcnt(6)
    v_mfma_f32_32x32x16_bf16 v[16:31], v[64:67], v[208:211], v[16:31]
    ds_read_b128 v[60:63], v3 offset:27648
    s_waitcnt lgkmcnt(6)
    v_mfma_f32_32x32x16_bf16 v[16:31], v[68:71], v[212:215], v[16:31]
    s_add_u32 m0, s74, 99328
    s_add_u32 s55, s73, 57344
    buffer_load_dwordx4 v112, s[8:11], s55 offen lds
    ds_read_b128 v[64:67], v3 offset:28672
    s_waitcnt lgkmcnt(6)
    v_mfma_f32_32x32x16_bf16 v[16:31], v[72:75], v[216:219], v[16:31]
    ds_read_b128 v[68:71], v3 offset:29696
    s_waitcnt lgkmcnt(6)
    v_mfma_f32_32x32x16_bf16 v[16:31], v[76:79], v[220:223], v[16:31]
    ds_read_b128 v[72:75], v3 offset:30720
    s_waitcnt lgkmcnt(6)
    v_mfma_f32_32x32x16_bf16 v[16:31], v[48:51], v[224:227], v[16:31]
    ds_read_b128 v[76:79], v3 offset:31744
    s_waitcnt lgkmcnt(6)
    v_mfma_f32_32x32x16_bf16 v[16:31], v[52:55], v[228:231], v[16:31]
    s_add_u32 m0, s74, 100352
    s_add_u32 s55, s73, 65536
    buffer_load_dwordx4 v112, s[8:11], s55 offen lds
    s_waitcnt lgkmcnt(5)
    v_mfma_f32_32x32x16_bf16 v[16:31], v[56:59], v[232:235], v[16:31]
    s_waitcnt lgkmcnt(4)
    v_mfma_f32_32x32x16_bf16 v[16:31], v[60:63], v[236:239], v[16:31]
    s_waitcnt lgkmcnt(3)
    v_mfma_f32_32x32x16_bf16 v[16:31], v[64:67], v[240:243], v[16:31]
    s_waitcnt lgkmcnt(2)
    v_mfma_f32_32x32x16_bf16 v[16:31], v[68:71], v[244:247], v[16:31]
    s_waitcnt lgkmcnt(1)
    v_mfma_f32_32x32x16_bf16 v[16:31], v[72:75], v[248:251], v[16:31]
    s_add_u32 m0, s74, 101376
    s_add_u32 s55, s73, 73728
    buffer_load_dwordx4 v112, s[8:11], s55 offen lds
    s_waitcnt lgkmcnt(0)
    v_mfma_f32_32x32x16_bf16 v[16:31], v[76:79], v[252:255], v[16:31]
    s_setprio 0
    s_waitcnt vmcnt(8)
    s_barrier
    ds_read_b128 v[64:67], v12 offset:768
    ds_read_b128 v[68:71], v12 offset:800
    ds_read_b128 v[72:75], v12 offset:832
    ds_read_b128 v[76:79], v12 offset:864
    s_waitcnt lgkmcnt(3)
    s_nop 3
    v_fmac_f32 v16, v4, v64
    v_fmac_f32 v17, v4, v65
    v_fmac_f32 v18, v4, v66
    v_fmac_f32 v19, v4, v67
    v_mul_f32 v80, v16, v16
    v_mul_f32 v81, v17, v17
    v_mul_f32 v82, v18, v18
    v_mul_f32 v83, v19, v19
    s_waitcnt lgkmcnt(2)
    v_fmac_f32 v20, v4, v68
    v_fmac_f32 v21, v4, v69
    v_fmac_f32 v22, v4, v70
    v_fmac_f32 v23, v4, v71
    v_mul_f32 v84, v20, v20
    v_mul_f32 v85, v21, v21
    v_mul_f32 v86, v22, v22
    v_mul_f32 v87, v23, v23
    s_waitcnt lgkmcnt(1)
    v_fmac_f32 v24, v4, v72
    v_fmac_f32 v25, v4, v73
    v_fmac_f32 v26, v4, v74
    v_fmac_f32 v27, v4, v75
    s_waitcnt lgkmcnt(0)
    v_fmac_f32 v28, v4, v76
    v_fmac_f32 v29, v4, v77
    v_fmac_f32 v30, v4, v78
    v_fmac_f32 v31, v4, v79
    v_fma_f32 v80, v80, v113, v6
    v_fma_f32 v81, v81, v113, v6
    v_fma_f32 v82, v82, v113, v6
    v_fma_f32 v83, v83, v113, v6
    v_fma_f32 v84, v84, v113, v6
    v_fma_f32 v85, v85, v113, v6
    v_fma_f32 v86, v86, v113, v6
    v_fma_f32 v87, v87, v113, v6
    v_mul_f32 v80, v80, v16
    v_mul_f32 v81, v81, v17
    v_mul_f32 v82, v82, v18
    v_mul_f32 v83, v83, v19
    v_mul_f32 v84, v84, v20
    v_mul_f32 v85, v85, v21
    v_mul_f32 v86, v86, v22
    v_mul_f32 v87, v87, v23
    v_exp_f32 v80, v80
    v_mul_f32 v16, v16, v24
    v_exp_f32 v81, v81
    v_mul_f32 v17, v17, v25
    v_exp_f32 v82, v82
    v_mul_f32 v18, v18, v26
    v_exp_f32 v83, v83
    v_mul_f32 v19, v19, v27
    v_exp_f32 v84, v84
    v_mul_f32 v20, v20, v28
    v_exp_f32 v85, v85
    v_mul_f32 v21, v21, v29
    v_exp_f32 v86, v86
    v_mul_f32 v22, v22, v30
    v_exp_f32 v87, v87
    v_mul_f32 v23, v23, v31
    v_fma_f32 v80, v80, v114, v114
    v_fma_f32 v81, v81, v114, v114
    v_fma_f32 v82, v82, v114, v114
    v_fma_f32 v83, v83, v114, v114
    v_fma_f32 v84, v84, v114, v114
    v_fma_f32 v85, v85, v114, v114
    v_fma_f32 v86, v86, v114, v114
    v_fma_f32 v87, v87, v114, v114
    v_rcp_f32 v80, v80
    v_rcp_f32 v81, v81
    v_rcp_f32 v82, v82
    v_rcp_f32 v83, v83
    v_rcp_f32 v84, v84
    v_rcp_f32 v85, v85
    v_rcp_f32 v86, v86
    v_rcp_f32 v87, v87
    v_mul_f32 v16, v16, v80
    v_mul_f32 v17, v17, v81
    v_cvt_pk_bf16_f32 v88, v16, v17
    v_mul_f32 v18, v18, v82
    v_mul_f32 v19, v19, v83
    v_cvt_pk_bf16_f32 v89, v18, v19
    v_mul_f32 v20, v20, v84
    v_mul_f32 v21, v21, v85
    v_cvt_pk_bf16_f32 v90, v20, v21
    v_mul_f32 v22, v22, v86
    v_mul_f32 v23, v23, v87
    v_cvt_pk_bf16_f32 v91, v22, v23
    v_permlane32_swap_b32 v88, v90
    s_nop 0
    v_permlane32_swap_b32 v89, v91
    s_add_u32 s58, s78, 6144
    buffer_store_dwordx4 v[88:91], v7, s[4:7], s58 offen sc1
    s_add_u32 s55, s18, 0
    buffer_load_dwordx4 v[128:131], v7, s[4:7], s55 offen
    s_add_u32 s55, s18, 1024
    buffer_load_dwordx4 v[132:135], v7, s[4:7], s55 offen
    s_add_u32 s55, s18, 2048
    buffer_load_dwordx4 v[136:139], v7, s[4:7], s55 offen
    s_add_u32 s55, s18, 28672
    buffer_load_dwordx4 v[140:143], v7, s[4:7], s55 offen
    s_add_u32 s55, s18, 29696
    buffer_load_dwordx4 v[144:147], v7, s[4:7], s55 offen
    s_add_u32 s55, s18, 30720
    buffer_load_dwordx4 v[148:151], v7, s[4:7], s55 offen
    s_add_u32 s55, s18, 57344
    buffer_load_dwordx4 v[152:155], v7, s[4:7], s55 offen
    s_add_u32 s55, s18, 58368
    buffer_load_dwordx4 v[156:159], v7, s[4:7], s55 offen
    s_add_u32 s55, s18, 59392
    buffer_load_dwordx4 v[160:163], v7, s[4:7], s55 offen
    s_add_u32 s55, s18, 86016
    buffer_load_dwordx4 v[164:167], v7, s[4:7], s55 offen
    s_add_u32 s55, s18, 87040
    buffer_load_dwordx4 v[168:171], v7, s[4:7], s55 offen
    s_add_u32 s55, s18, 88064
    buffer_load_dwordx4 v[172:175], v7, s[4:7], s55 offen
    s_branch L_join_39
L_grpB_38:
    v_mov_b32 v124, 0x3f803f80
    v_mov_b32 v125, 0x3f803f80
    s_waitcnt vmcnt(4) lgkmcnt(0)
    s_barrier
    ds_read_b64_tr_b16 v[128:129], v2 offset:0
    ds_read_b64_tr_b16 v[130:131], v2 offset:1024
    ds_read_b128 v[48:51], v3 offset:0
    ds_read_b64_tr_b16 v[132:133], v2 offset:4096
    ds_read_b64_tr_b16 v[134:135], v2 offset:5120
    ds_read_b128 v[52:55], v3 offset:1024
    s_lshl_b32 s56, s3, 10
    s_add_u32 m0, s56, 40960
    s_mov_b32 s55, 1703936
    buffer_load_dwordx4 v13, s[4:7], s55 offen lds
    s_waitcnt vmcnt(4) lgkmcnt(0)
    s_barrier
    v_mfma_f32_32x32x16_bf16 v[16:31], v[48:51], v[128:131], 0
    ds_read_b64_tr_b16 v[136:137], v2 offset:8192
    ds_read_b64_tr_b16 v[138:139], v2 offset:9216
    ds_read_b128 v[56:59], v3 offset:2048
    ds_read_b64_tr_b16 v[140:141], v2 offset:12288
    ds_read_b64_tr_b16 v[142:143], v2 offset:13312
    ds_read_b128 v[60:63], v3 offset:3072
    v_mfma_f32_4x4x4_16b_bf16 v[116:119], v[124:125], v[130:131], 0
    v_mfma_f32_4x4x4_16b_bf16 v[120:123], v[130:131], v[130:131], 0
    v_mfma_f32_32x32x16_bf16 v[16:31], v[52:55], v[132:135], v[16:31]
    v_mfma_f32_4x4x4_16b_bf16 v[116:119], v[124:125], v[134:135], v[116:119]
    v_mfma_f32_4x4x4_16b_bf16 v[120:123], v[134:135], v[134:135], v[120:123]
    s_lshl_b32 s56, s3, 10
    s_add_u32 m0, s56, 0
    s_mov_b32 s55, 1835008
    buffer_load_dwordx4 v13, s[4:7], s55 offen lds
    s_waitcnt vmcnt(4) lgkmcnt(0)
    s_barrier
    v_mfma_f32_32x32x16_bf16 v[16:31], v[56:59], v[136:139], v[16:31]
    ds_read_b64_tr_b16 v[144:145], v2 offset:16384
    ds_read_b64_tr_b16 v[146:147], v2 offset:17408
    ds_read_b128 v[48:51], v3 offset:4096
    ds_read_b64_tr_b16 v[148:149], v2 offset:20480
    ds_read_b64_tr_b16 v[150:151], v2 offset:21504
    ds_read_b128 v[52:55], v3 offset:5120
    v_mfma_f32_4x4x4_16b_bf16 v[116:119], v[124:125], v[138:139], v[116:119]
    v_mfma_f32_4x4x4_16b_bf16 v[120:123], v[138:139], v[138:139], v[120:123]
    v_mfma_f32_32x32x16_bf16 v[16:31], v[60:63], v[140:143], v[16:31]
    v_mfma_f32_4x4x4_16b_bf16 v[116:119], v[124:125], v[142:143], v[116:119]
    v_mfma_f32_4x4x4_16b_bf16 v[120:123], v[142:143], v[142:143], v[120:123]
    s_lshl_b32 s56, s3, 10
    s_add_u32 m0, s56, 8192
    s_mov_b32 s55, 1966080
    buffer_load_dwordx4 v13, s[4:7], s55 offen lds
    s_waitcnt vmcnt(4) lgkmcnt(0)
    s_barrier
    v_mfma_f32_32x32x16_bf16 v[16:31], v[48:51], v[144:147], v[16:31]
    ds_read_b64_tr_b16 v[152:153], v2 offset:24576
    ds_read_b64_tr_b16 v[154:155], v2 offset:25600
    ds_read_b128 v[56:59], v3 offset:6144
    ds_read_b64_tr_b16 v[156:157], v2 offset:28672
    ds_read_b64_tr_b16 v[158:159], v2 offset:29696
    ds_read_b128 v[60:63], v3 offset:7168
    v_mfma_f32_4x4x4_16b_bf16 v[116:119], v[124:125], v[146:147], v[116:119]
    v_mfma_f32_4x4x4_16b_bf16 v[120:123], v[146:147], v[146:147], v[120:123]
    v_mfma_f32_32x32x16_bf16 v[16:31], v[52:55], v[148:151], v[16:31]
    v_mfma_f32_4x4x4_16b_bf16 v[116:119], v[124:125], v[150:151], v[116:119]
    v_mfma_f32_4x4x4_16b_bf16 v[120:123], v[150:151], v[150:151], v[120:123]
    s_lshl_b32 s56, s3, 10
    s_add_u32 m0, s56, 16384
    s_mov_b32 s55, 2097152
    buffer_load_dwordx4 v13, s[4:7], s55 offen lds
    s_lshl_b32 s56, s3, 12
    s_add_u32 s55, s77, s56
    s_add_u32 s55, s55, 65536
    s_add_u32 m0, s56, 115712
    s_nop 0
    buffer_load_dwordx4 v7, s[4:7], s55 offen offset:0 lds
    buffer_load_dwordx4 v7, s[4:7], s55 offen offset:1024 lds
    buffer_load_dwordx4 v7, s[4:7], s55 offen offset:2048 lds
    buffer_load_dwordx4 v7, s[4:7], s55 offen offset:3072 lds
    s_waitcnt vmcnt(8) lgkmcnt(0)
    s_barrier
    v_mfma_f32_32x32x16_bf16 v[16:31], v[56:59], v[152:155], v[16:31]
    ds_read_b64_tr_b16 v[160:161], v2 offset:32768
    ds_read_b64_tr_b16 v[162:163], v2 offset:33792
    ds_read_b128 v[48:51], v3 offset:8192
    ds_read_b64_tr_b16 v[164:165], v2 offset:36864
    ds_read_b64_tr_b16 v[166:167], v2 offset:37888
    ds_read_b128 v[52:55], v3 offset:9216
    v_mfma_f32_4x4x4_16b_bf16 v[116:119], v[124:125], v[154:155], v[116:119]
    v_mfma_f32_4x4x4_16b_bf16 v[120:123], v[154:155], v[154:155], v[120:123]
    v_mfma_f32_32x32x16_bf16 v[16:31], v[60:63], v[156:159], v[16:31]
    v_mfma_f32_4x4x4_16b_bf16 v[116:119], v[124:125], v[158:159], v[116:119]
    v_mfma_f32_4x4x4_16b_bf16 v[120:123], v[158:159], v[158:159], v[120:123]
    s_lshl_b32 s56, s3, 10
    s_add_u32 m0, s56, 24576
    s_mov_b32 s55, 2228224
    buffer_load_dwordx4 v13, s[4:7], s55 offen lds
    s_waitcnt vmcnt(8) lgkmcnt(0)
    s_barrier
    v_mfma_f32_32x32x16_bf16 v[16:31], v[48:51], v[160:163], v[16:31]
    ds_read_b64_tr_b16 v[168:169], v2 offset:40960
    ds_read_b64_tr_b16 v[170:171], v2 offset:41984
    ds_read_b128 v[56:59], v3 offset:10240
    ds_read_b64_tr_b16 v[172:173], v2 offset:45056
    ds_read_b64_tr_b16 v[174:175], v2 offset:46080
    ds_read_b128 v[60:63], v3 offset:11264
    v_mfma_f32_4x4x4_16b_bf16 v[116:119], v[124:125], v[162:163], v[116:119]
    v_mfma_f32_4x4x4_16b_bf16 v[120:123], v[162:163], v[162:163], v[120:123]
    v_mfma_f32_32x32x16_bf16 v[16:31], v[52:55], v[164:167], v[16:31]
    v_mfma_f32_4x4x4_16b_bf16 v[116:119], v[124:125], v[166:167], v[116:119]
    v_mfma_f32_4x4x4_16b_bf16 v[120:123], v[166:167], v[166:167], v[120:123]
    s_lshl_b32 s56, s3, 10
    s_add_u32 m0, s56, 32768
    s_mov_b32 s55, 2359296
    buffer_load_dwordx4 v13, s[4:7], s55 offen lds
    s_waitcnt vmcnt(8) lgkmcnt(0)
    s_barrier
    v_mfma_f32_32x32x16_bf16 v[16:31], v[56:59], v[168:171], v[16:31]
    ds_read_b64_tr_b16 v[176:177], v2 offset:0
    ds_read_b64_tr_b16 v[178:179], v2 offset:1024
    ds_read_b128 v[48:51], v3 offset:12288
    ds_read_b64_tr_b16 v[180:181], v2 offset:4096
    ds_read_b64_tr_b16 v[182:183], v2 offset:5120
    ds_read_b128 v[52:55], v3 offset:13312
    v_mfma_f32_4x4x4_16b_bf16 v[116:119], v[124:125], v[170:171], v[116:119]
    v_mfma_f32_4x4x4_16b_bf16 v[120:123], v[170:171], v[170:171], v[120:123]
    v_mfma_f32_32x32x16_bf16 v[16:31], v[60:63], v[172:175], v[16:31]
    v_mfma_f32_4x4x4_16b_bf16 v[116:119], v[124:125], v[174:175], v[116:119]
    v_mfma_f32_4x4x4_16b_bf16 v[120:123], v[174:175], v[174:175], v[120:123]
    s_lshl_b32 s56, s3, 10
    s_add_u32 m0, s56, 40960
    s_mov_b32 s55, 2490368
    buffer_load_dwordx4 v13, s[4:7], s55 offen lds
    s_waitcnt vmcnt(8) lgkmcnt(0)
    s_barrier
    v_mfma_f32_32x32x16_bf16 v[16:31], v[48:51], v[176:179], v[16:31]
    ds_read_b64_tr_b16 v[184:185], v2 offset:8192
    ds_read_b64_tr_b16 v[186:187], v2 offset:9216
    ds_read_b128 v[56:59], v3 offset:14336
    ds_read_b64_tr_b16 v[188:189], v2 offset:12288
    ds_read_b64_tr_b16 v[190:191], v2 offset:13312
    ds_read_b128 v[60:63], v3 offset:15360
    v_mfma_f32_4x4x4_16b_bf16 v[116:119], v[124:125], v[178:179], v[116:119]
    v_mfma_f32_4x4x4_16b_bf16 v[120:123], v[178:179], v[178:179], v[120:123]
    v_mfma_f32_32x32x16_bf16 v[16:31], v[52:55], v[180:183], v[16:31]
    v_mfma_f32_4x4x4_16b_bf16 v[116:119], v[124:125], v[182:183], v[116:119]
    v_mfma_f32_4x4x4_16b_bf16 v[120:123], v[182:183], v[182:183], v[120:123]
    s_lshl_b32 s56, s3, 10
    s_add_u32 m0, s56, 0
    s_mov_b32 s55, 2621440
    buffer_load_dwordx4 v13, s[4:7], s55 offen lds
    s_waitcnt vmcnt(8) lgkmcnt(0)
    s_barrier
    v_mfma_f32_32x32x16_bf16 v[16:31], v[56:59], v[184:187], v[16:31]
    ds_read_b64_tr_b16 v[192:193], v2 offset:16384
    ds_read_b64_tr_b16 v[194:195], v2 offset:17408
    ds_read_b128 v[48:51], v3 offset:16384
    ds_read_b64_tr_b16 v[196:197], v2 offset:20480
    ds_read_b64_tr_b16 v[198:199], v2 offset:21504
    ds_read_b128 v[52:55], v3 offset:17408
    v_mfma_f32_4x4x4_16b_bf16 v[116:119], v[124:125], v[186:187], v[116:119]
    v_mfma_f32_4x4x4_16b_bf16 v[120:123], v[186:187], v[186:187], v[120:123]
    v_mfma_f32_32x32x16_bf16 v[16:31], v[60:63], v[188:191], v[16:31]
    v_mfma_f32_4x4x4_16b_bf16 v[116:119], v[124:125], v[190:191], v[116:119]
    v_mfma_f32_4x4x4_16b_bf16 v[120:123], v[190:191], v[190:191], v[120:123]
    s_lshl_b32 s56, s3, 10
    s_add_u32 m0, s56, 8192
    s_mov_b32 s55, 2752512
    buffer_load_dwordx4 v13, s[4:7], s55 offen lds
    s_waitcnt vmcnt(4) lgkmcnt(0)
    s_barrier
    v_mfma_f32_32x32x16_bf16 v[16:31], v[48:51], v[192:195], v[16:31]
    ds_read_b64_tr_b16 v[200:201], v2 offset:24576
    ds_read_b64_tr_b16 v[202:203], v2 offset:25600
    ds_read_b128 v[56:59], v3 offset:18432
    ds_read_b64_tr_b16 v[204:205], v2 offset:28672
    ds_read_b64_tr_b16 v[206:207], v2 offset:29696
    ds_read_b128 v[60:63], v3 offset:19456
    v_mfma_f32_4x4x4_16b_bf16 v[116:119], v[124:125], v[194:195], v[116:119]
    v_mfma_f32_4x4x4_16b_bf16 v[120:123], v[194:195], v[194:195], v[120:123]
    v_mfma_f32_32x32x16_bf16 v[16:31], v[52:55], v[196:199], v[16:31]
    v_mfma_f32_4x4x4_16b_bf16 v[116:119], v[124:125], v[198:199], v[116:119]
    v_mfma_f32_4x4x4_16b_bf16 v[120:123], v[198:199], v[198:199], v[120:123]
    s_lshl_b32 s56, s3, 10
    s_add_u32 m0, s56, 16384
    s_mov_b32 s55, 2883584
    buffer_load_dwordx4 v13, s[4:7], s55 offen lds
    s_waitcnt vmcnt(4) lgkmcnt(0)
    s_barrier
    v_mfma_f32_32x32x16_bf16 v[16:31], v[56:59], v[200:203], v[16:31]
    ds_read_b64_tr_b16 v[208:209], v2 offset:32768
    ds_read_b64_tr_b16 v[210:211], v2 offset:33792
    ds_read_b128 v[48:51], v3 offset:20480
    ds_read_b64_tr_b16 v[212:213], v2 offset:36864
    ds_read_b64_tr_b16 v[214:215], v2 offset:37888
    ds_read_b128 v[52:55], v3 offset:21504
    v_mfma_f32_4x4x4_16b_bf16 v[116:119], v[124:125], v[202:203], v[116:119]
    v_mfma_f32_4x4x4_16b_bf16 v[120:123], v[202:203], v[202:203], v[120:123]
    v_mfma_f32_32x32x16_bf16 v[16:31], v[60:63], v[204:207], v[16:31]
    v_mfma_f32_4x4x4_16b_bf16 v[116:119], v[124:125], v[206:207], v[116:119]
    v_mfma_f32_4x4x4_16b_bf16 v[120:123], v[206:207], v[206:207], v[120:123]
    s_lshl_b32 s56, s3, 10
    s_add_u32 m0, s56, 24576
    s_mov_b32 s55, 3014656
    buffer_load_dwordx4 v13, s[4:7], s55 offen lds
    s_waitcnt vmcnt(4) lgkmcnt(0)
    s_barrier
    v_mfma_f32_32x32x16_bf16 v[16:31], v[48:51], v[208:211], v[16:31]
    ds_read_b64_tr_b16 v[216:217], v2 offset:40960
    ds_read_b64_tr_b16 v[218:219], v2 offset:41984
    ds_read_b128 v[56:59], v3 offset:22528
    ds_read_b64_tr_b16 v[220:221], v2 offset:45056
    ds_read_b64_tr_b16 v[222:223], v2 offset:46080
    ds_read_b128 v[60:63], v3 offset:23552
    v_mfma_f32_4x4x4_16b_bf16 v[116:119], v[124:125], v[210:211], v[116:119]
    v_mfma_f32_4x4x4_16b_bf16 v[120:123], v[210:211], v[210:211], v[120:123]
    v_mfma_f32_32x32x16_bf16 v[16:31], v[52:55], v[212:215], v[16:31]
    v_mfma_f32_4x4x4_16b_bf16 v[116:119], v[124:125], v[214:215], v[116:119]
    v_mfma_f32_4x4x4_16b_bf16 v[120:123], v[214:215], v[214:215], v[120:123]
    s_waitcnt vmcnt(3) lgkmcnt(0)
    s_barrier
    v_mfma_f32_32x32x16_bf16 v[16:31], v[56:59], v[216:219], v[16:31]
    ds_read_b64_tr_b16 v[224:225], v2 offset:0
    ds_read_b64_tr_b16 v[226:227], v2 offset:1024
    ds_read_b128 v[48:51], v3 offset:24576
    ds_read_b64_tr_b16 v[228:229], v2 offset:4096
    ds_read_b64_tr_b16 v[230:231], v2 offset:5120
    ds_read_b128 v[52:55], v3 offset:25600
    v_mfma_f32_4x4x4_16b_bf16 v[116:119], v[124:125], v[218:219], v[116:119]
    v_mfma_f32_4x4x4_16b_bf16 v[120:123], v[218:219], v[218:219], v[120:123]
    v_mfma_f32_32x32x16_bf16 v[16:31], v[60:63], v[220:223], v[16:31]
    v_mfma_f32_4x4x4_16b_bf16 v[116:119], v[124:125], v[222:223], v[116:119]
    v_mfma_f32_4x4x4_16b_bf16 v[120:123], v[222:223], v[222:223], v[120:123]
    s_waitcnt vmcnt(2) lgkmcnt(0)
    s_barrier
    v_mfma_f32_32x32x16_bf16 v[16:31], v[48:51], v[224:227], v[16:31]
    ds_read_b64_tr_b16 v[232:233], v2 offset:8192
    ds_read_b64_tr_b16 v[234:235], v2 offset:9216
    ds_read_b128 v[56:59], v3 offset:26624
    ds_read_b64_tr_b16 v[236:237], v2 offset:12288
    ds_read_b64_tr_b16 v[238:239], v2 offset:13312
    ds_read_b128 v[60:63], v3 offset:27648
    v_mfma_f32_4x4x4_16b_bf16 v[116:119], v[124:125], v[226:227], v[116:119]
    v_mfma_f32_4x4x4_16b_bf16 v[120:123], v[226:227], v[226:227], v[120:123]
    v_mfma_f32_32x32x16_bf16 v[16:31], v[52:55], v[228:231], v[16:31]
    v_mfma_f32_4x4x4_16b_bf16 v[116:119], v[124:125], v[230:231], v[116:119]
    v_mfma_f32_4x4x4_16b_bf16 v[120:123], v[230:231], v[230:231], v[120:123]
    s_waitcnt vmcnt(1) lgkmcnt(0)
    s_barrier
    v_mfma_f32_32x32x16_bf16 v[16:31], v[56:59], v[232:235], v[16:31]
    ds_read_b64_tr_b16 v[240:241], v2 offset:16384
    ds_read_b64_tr_b16 v[242:243], v2 offset:17408
    ds_read_b128 v[48:51], v3 offset:28672
    ds_read_b64_tr_b16 v[244:245], v2 offset:20480
    ds_read_b64_tr_b16 v[246:247], v2 offset:21504
    ds_read_b128 v[52:55], v3 offset:29696
    v_mfma_f32_4x4x4_16b_bf16 v[116:119], v[124:125], v[234:235], v[116:119]
    v_mfma_f32_4x4x4_16b_bf16 v[120:123], v[234:235], v[234:235], v[120:123]
    v_mfma_f32_32x32x16_bf16 v[16:31], v[60:63], v[236:239], v[16:31]
    v_mfma_f32_4x4x4_16b_bf16 v[116:119], v[124:125], v[238:239], v[116:119]
    v_mfma_f32_4x4x4_16b_bf16 v[120:123], v[238:239], v[238:239], v[120:123]
    s_waitcnt vmcnt(0) lgkmcnt(0)
    s_barrier
    v_mfma_f32_32x32x16_bf16 v[16:31], v[48:51], v[240:243], v[16:31]
    ds_read_b64_tr_b16 v[248:249], v2 offset:24576
    ds_read_b64_tr_b16 v[250:251], v2 offset:25600
    ds_read_b128 v[56:59], v3 offset:30720
    ds_read_b64_tr_b16 v[252:253], v2 offset:28672
    ds_read_b64_tr_b16 v[254:255], v2 offset:29696
    ds_read_b128 v[60:63], v3 offset:31744
    v_mfma_f32_4x4x4_16b_bf16 v[116:119], v[124:125], v[242:243], v[116:119]
    v_mfma_f32_4x4x4_16b_bf16 v[120:123], v[242:243], v[242:243], v[120:123]
    v_mfma_f32_32x32x16_bf16 v[16:31], v[52:55], v[244:247], v[16:31]
    v_mfma_f32_4x4x4_16b_bf16 v[116:119], v[124:125], v[246:247], v[116:119]
    v_mfma_f32_4x4x4_16b_bf16 v[120:123], v[246:247], v[246:247], v[120:123]
    s_waitcnt lgkmcnt(0)
    v_mfma_f32_32x32x16_bf16 v[16:31], v[56:59], v[248:251], v[16:31]
    v_mfma_f32_4x4x4_16b_bf16 v[116:119], v[124:125], v[250:251], v[116:119]
    v_mfma_f32_4x4x4_16b_bf16 v[120:123], v[250:251], v[250:251], v[120:123]
    v_mfma_f32_32x32x16_bf16 v[16:31], v[60:63], v[252:255], v[16:31]
    v_mfma_f32_4x4x4_16b_bf16 v[116:119], v[124:125], v[254:255], v[116:119]
    v_mfma_f32_4x4x4_16b_bf16 v[120:123], v[254:255], v[254:255], v[120:123]
    v_and_b32 v14, 3, v0
    v_cmp_eq_u32 vcc, 1, v14
    s_nop 2
    v_cndmask_b32 v10, v120, v121, vcc
    v_cmp_eq_u32 vcc, 2, v14
    s_nop 1
    v_cndmask_b32 v10, v10, v122, vcc
    v_cmp_eq_u32 vcc, 3, v14
    s_nop 1
    v_cndmask_b32 v10, v10, v123, vcc
    v_mov_b32 v8, v116
    v_mov_b32 v9, v116
    v_mov_b32 v11, v10
    s_nop 0
    v_permlane32_swap_b32 v8, v9
    v_permlane32_swap_b32 v10, v11
    v_add_f32 v8, v8, v9
    v_add_f32 v9, v10, v11
    s_lshl_b32 s59, s3, 9
    s_add_u32 s59, s59, 151552
    v_lshl_add_u32 v14, v0, 3, s59
    ds_write_b64 v14, v[8:9]
    v_xor_b32 v14, 2048, v14
    s_waitcnt lgkmcnt(0)
    s_barrier
    ds_read_b64 v[10:11], v14
    s_waitcnt lgkmcnt(0)
    v_add_f32 v8, v8, v10
    v_add_f32 v10, v9, v11
    v_mul_f32 v8, 0x3b000000, v8
    v_mul_f32 v10, 0x3b000000, v10
    v_fma_f32 v10, -v8, v8, v10
    v_max_f32 v10, 0, v10
    v_cvt_pk_bf16_f32 v14, v10, v10
    v_lshlrev_b32 v14, 16, v14
    v_add_f32 v14, 0x3727c5ac, v14
    v_cvt_pk_bf16_f32 v14, v14, v14
    v_lshlrev_b32 v14, 16, v14
    v_sqrt_f32 v14, v14
    s_nop 0
    v_cvt_pk_bf16_f32 v15, v14, v14
    v_lshlrev_b32 v10, 16, v15
    v_cvt_pk_bf16_f32 v14, v8, v8
    v_rcp_f32 v5, v10
    v_lshlrev_b32 v14, 16, v14
    v_sub_f32 v4, 0, v14
    v_mul_f32 v114, v10, v10
    v_mul_f32 v6, 0xc0135761, v5
    v_mul_f32 v113, v5, v5
    v_mul_f32 v113, v113, v5
    v_mul_f32 v113, 0xbdd2d3e8, v113
    ds_read_b128 v[64:67], v12 offset:128
    ds_read_b128 v[68:71], v12 offset:160
    ds_read_b128 v[72:75], v12 offset:192
    ds_read_b128 v[76:79], v12 offset:224
    s_waitcnt lgkmcnt(3)
    v_fmac_f32 v16, v4, v64
    v_fmac_f32 v17, v4, v65
    v_fmac_f32 v18, v4, v66
    v_fmac_f32 v19, v4, v67
    v_mul_f32 v80, v16, v16
    v_mul_f32 v81, v17, v17
    v_mul_f32 v82, v18, v18
    v_mul_f32 v83, v19, v19
    s_waitcnt lgkmcnt(2)
    v_fmac_f32 v20, v4, v68
    v_fmac_f32 v21, v4, v69
    v_fmac_f32 v22, v4, v70
    v_fmac_f32 v23, v4, v71
    v_mul_f32 v84, v20, v20
    v_mul_f32 v85, v21, v21
    v_mul_f32 v86, v22, v22
    v_mul_f32 v87, v23, v23
    s_waitcnt lgkmcnt(1)
    v_fmac_f32 v24, v4, v72
    v_fmac_f32 v25, v4, v73
    v_fmac_f32 v26, v4, v74
    v_fmac_f32 v27, v4, v75
    s_waitcnt lgkmcnt(0)
    v_fmac_f32 v28, v4, v76
    v_fmac_f32 v29, v4, v77
    v_fmac_f32 v30, v4, v78
    v_fmac_f32 v31, v4, v79
    v_fma_f32 v80, v80, v113, v6
    v_fma_f32 v81, v81, v113, v6
    v_fma_f32 v82, v82, v113, v6
    v_fma_f32 v83, v83, v113, v6
    v_fma_f32 v84, v84, v113, v6
    v_fma_f32 v85, v85, v113, v6
    v_fma_f32 v86, v86, v113, v6
    v_fma_f32 v87, v87, v113, v6
    v_mul_f32 v80, v80, v16
    v_mul_f32 v81, v81, v17
    v_mul_f32 v82, v82, v18
    v_mul_f32 v83, v83, v19
    v_mul_f32 v84, v84, v20
    v_mul_f32 v85, v85, v21
    v_mul_f32 v86, v86, v22
    v_mul_f32 v87, v87, v23
    v_exp_f32 v80, v80
    v_mul_f32 v16, v16, v24
    v_exp_f32 v81, v81
    v_mul_f32 v17, v17, v25
    v_exp_f32 v82, v82
    v_mul_f32 v18, v18, v26
    v_exp_f32 v83, v83
    v_mul_f32 v19, v19, v27
    v_exp_f32 v84, v84
    v_mul_f32 v20, v20, v28
    v_exp_f32 v85, v85
    v_mul_f32 v21, v21, v29
    v_exp_f32 v86, v86
    v_mul_f32 v22, v22, v30
    v_exp_f32 v87, v87
    v_mul_f32 v23, v23, v31
    v_fma_f32 v80, v80, v114, v114
    v_fma_f32 v81, v81, v114, v114
    v_fma_f32 v82, v82, v114, v114
    v_fma_f32 v83, v83, v114, v114
    v_fma_f32 v84, v84, v114, v114
    v_fma_f32 v85, v85, v114, v114
    v_fma_f32 v86, v86, v114, v114
    v_fma_f32 v87, v87, v114, v114
    v_rcp_f32 v80, v80
    v_rcp_f32 v81, v81
    v_rcp_f32 v82, v82
    v_rcp_f32 v83, v83
    v_rcp_f32 v84, v84
    v_rcp_f32 v85, v85
    v_rcp_f32 v86, v86
    v_rcp_f32 v87, v87
    v_mul_f32 v16, v16, v80
    v_mul_f32 v17, v17, v81
    v_cvt_pk_bf16_f32 v88, v16, v17
    v_mul_f32 v18, v18, v82
    v_mul_f32 v19, v19, v83
    v_cvt_pk_bf16_f32 v89, v18, v19
    v_mul_f32 v20, v20, v84
    v_mul_f32 v21, v21, v85
    v_cvt_pk_bf16_f32 v90, v20, v21
    v_mul_f32 v22, v22, v86
    v_mul_f32 v23, v23, v87
    v_cvt_pk_bf16_f32 v91, v22, v23
    v_permlane32_swap_b32 v88, v90
    s_nop 0
    v_permlane32_swap_b32 v89, v91
    s_add_u32 s58, s78, 1024
    buffer_store_dwordx4 v[88:91], v7, s[4:7], s58 offen sc1
    s_barrier
    v_add_u32 v3, 0, v7
    s_setprio 1
    ds_read_b128 v[48:51], v3 offset:0
    ds_read_b128 v[52:55], v3 offset:1024
    ds_read_b128 v[56:59], v3 offset:2048
    ds_read_b128 v[60:63], v3 offset:3072
    ds_read_b128 v[64:67], v3 offset:4096
    ds_read_b128 v[68:71], v3 offset:5120
    ds_read_b128 v[72:75], v3 offset:6144
    s_waitcnt lgkmcnt(6)
    v_mfma_f32_32x32x16_bf16 v[16:31], v[48:51], v[128:131], 0
    ds_read_b128 v[76:79], v3 offset:7168
    s_waitcnt lgkmcnt(6)
    v_mfma_f32_32x32x16_bf16 v[16:31], v[52:55], v[132:135], v[16:31]
    s_add_u32 m0, s72, 82944
    s_add_u32 s55, s71, 163840
    buffer_load_dwordx4 v7, s[4:7], s55 offen lds
    ds_read_b128 v[48:51], v3 offset:8192
    s_waitcnt lgkmcnt(6)
    v_mfma_f32_32x32x16_bf16 v[16:31], v[56:59], v[136:139], v[16:31]
    s_add_u32 m0, s72, 83968
    s_add_u32 s55, s71, 164864
    buffer_load_dwordx4 v7, s[4:7], s55 offen lds
    ds_read_b128 v[52:55], v3 offset:9216
    s_waitcnt lgkmcnt(6)
    v_mfma_f32_32x32x16_bf16 v[16:31], v[60:63], v[140:143], v[16:31]
    ds_read_b128 v[56:59], v3 offset:10240
    s_waitcnt lgkmcnt(6)
    v_mfma_f32_32x32x16_bf16 v[16:31], v[64:67], v[144:147], v[16:31]
    s_add_u32 m0, s72, 84992
    s_add_u32 s55, s71, 165888
    buffer_load_dwordx4 v7, s[4:7], s55 offen lds
    ds_read_b128 v[60:63], v3 offset:11264
    s_waitcnt lgkmcnt(6)
    v_mfma_f32_32x32x16_bf16 v[16:31], v[68:71], v[148:151], v[16:31]
    ds_read_b128 v[64:67], v3 offset:12288
    s_waitcnt lgkmcnt(6)
    v_mfma_f32_32x32x16_bf16 v[16:31], v[72:75], v[152:155], v[16:31]
    s_add_u32 m0, s72, 86016
    s_add_u32 s55, s71, 166912
    buffer_load_dwordx4 v7, s[4:7], s55 offen lds
    ds_read_b128 v[68:71], v3 offset:13312
    s_waitcnt lgkmcnt(6)
    v_mfma_f32_32x32x16_bf16 v[16:31], v[76:79], v[156:159], v[16:31]
    ds_read_b128 v[72:75], v3 offset:14336
    s_waitcnt lgkmcnt(6)
    v_mfma_f32_32x32x16_bf16 v[16:31], v[48:51], v[160:163], v[16:31]
    s_add_u32 m0, s72, 87040
    s_add_u32 s55, s71, 167936
    buffer_load_dwordx4 v7, s[4:7], s55 offen lds
    ds_read_b128 v[76:79], v3 offset:15360
    s_waitcnt lgkmcnt(6)
    v_mfma_f32_32x32x16_bf16 v[16:31], v[52:55], v[164:167], v[16:31]
    ds_read_b128 v[48:51], v3 offset:16384
    s_waitcnt lgkmcnt(6)
    v_mfma_f32_32x32x16_bf16 v[16:31], v[56:59], v[168:171], v[16:31]
    s_add_u32 m0, s72, 88064
    s_add_u32 s55, s71, 168960
    buffer_load_dwordx4 v7, s[4:7], s55 offen lds
    ds_read_b128 v[52:55], v3 offset:17408
    s_waitcnt lgkmcnt(6)
    v_mfma_f32_32x32x16_bf16 v[16:31], v[60:63], v[172:175], v[16:31]
    ds_read_b128 v[56:59], v3 offset:18432
    s_waitcnt lgkmcnt(6)
    v_mfma_f32_32x32x16_bf16 v[16:31], v[64:67], v[176:179], v[16:31]
    s_add_u32 m0, s72, 89088
    s_add_u32 s55, s71, 169984
    buffer_load_dwordx4 v7, s[4:7], s55 offen lds
    ds_read_b128 v[60:63], v3 offset:19456
    s_waitcnt lgkmcnt(6)
    v_mfma_f32_32x32x16_bf16 v[16:31], v[68:71], v[180:183], v[16:31]
    ds_read_b128 v[64:67], v3 offset:20480
    s_waitcnt lgkmcnt(6)
    v_mfma_f32_32x32x16_bf16 v[16:31], v[72:75], v[184:187], v[16:31]
    s_add_u32 m0, s72, 90112
    s_add_u32 s55, s71, 171008
    buffer_load_dwordx4 v7, s[4:7], s55 offen lds
    ds_read_b128 v[68:71], v3 offset:21504
    s_waitcnt lgkmcnt(6)
    v_mfma_f32_32x32x16_bf16 v[16:31], v[76:79], v[188:191], v[16:31]
    ds_read_b128 v[72:75], v3 offset:22528
    s_waitcnt lgkmcnt(6)
    v_mfma_f32_32x32x16_bf16 v[16:31], v[48:51], v[192:195], v[16:31]
    s_add_u32 m0, s72, 115712
    s_add_u32 s55, s71, 196608
    buffer_load_dwordx4 v7, s[4:7], s55 offen lds
    ds_read_b128 v[76:79], v3 offset:23552
    s_waitcnt lgkmcnt(6)
    v_mfma_f32_32x32x16_bf16 v[16:31], v[52:55], v[196:199], v[16:31]
    ds_read_b128 v[48:51], v3 offset:24576
    s_waitcnt lgkmcnt(6)
    v_mfma_f32_32x32x16_bf16 v[16:31], v[56:59], v[200:203], v[16:31]
    s_add_u32 m0, s72, 116736
    s_add_u32 s55, s71, 197632
    buffer_load_dwordx4 v7, s[4:7], s55 offen lds
    ds_read_b128 v[52:55], v3 offset:25600
    s_waitcnt lgkmcnt(6)
    v_mfma_f32_32x32x16_bf16 v[16:31], v[60:63], v[204:207], v[16:31]
    ds_read_b128 v[56:59], v3 offset:26624
    s_waitcnt lgkmcnt(6)
    v_mfma_f32_32x32x16_bf16 v[16:31], v[64:67], v[208:211], v[16:31]
    s_add_u32 m0, s72, 117760
    s_add_u32 s55, s71, 198656
    buffer_load_dwordx4 v7, s[4:7], s55 offen lds
    ds_read_b128 v[60:63], v3 offset:27648
    s_waitcnt lgkmcnt(6)
    v_mfma_f32_32x32x16_bf16 v[16:31], v[68:71], v[212:215], v[16:31]
    ds_read_b128 v[64:67], v3 offset:28672
    s_waitcnt lgkmcnt(6)
    v_mfma_f32_32x32x16_bf16 v[16:31], v[72:75], v[216:219], v[16:31]
    s_add_u32 m0, s72, 118784
    s_add_u32 s55, s71, 199680
    buffer_load_dwordx4 v7, s[4:7], s55 offen lds
    ds_read_b128 v[68:71], v3 offset:29696
    s_waitcnt lgkmcnt(6)
    v_mfma_f32_32x32x16_bf16 v[16:31], v[76:79], v[220:223], v[16:31]
    ds_read_b128 v[72:75], v3 offset:30720
    s_waitcnt lgkmcnt(6)
    v_mfma_f32_32x32x16_bf16 v[16:31], v[48:51], v[224:227], v[16:31]
    s_add_u32 m0, s72, 119808
    s_add_u32 s55, s71, 200704
    buffer_load_dwordx4 v7, s[4:7], s55 offen lds
    ds_read_b128 v[76:79], v3 offset:31744
    s_waitcnt lgkmcnt(6)
    v_mfma_f32_32x32x16_bf16 v[16:31], v[52:55], v[228:231], v[16:31]
    s_waitcnt lgkmcnt(5)
    v_mfma_f32_32x32x16_bf16 v[16:31], v[56:59], v[232:235], v[16:31]
    s_add_u32 m0, s72, 120832
    s_add_u32 s55, s71, 201728
    buffer_load_dwordx4 v7, s[4:7], s55 offen lds
    s_waitcnt lgkmcnt(4)
    v_mfma_f32_32x32x16_bf16 v[16:31], v[60:63], v[236:239], v[16:31]
    s_waitcnt lgkmcnt(3)
    v_mfma_f32_32x32x16_bf16 v[16:31], v[64:67], v[240:243], v[16:31]
    s_add_u32 m0, s72, 121856
    s_add_u32 s55, s71, 202752
    buffer_load_dwordx4 v7, s[4:7], s55 offen lds
    s_waitcnt lgkmcnt(2)
    v_mfma_f32_32x32x16_bf16 v[16:31], v[68:71], v[244:247], v[16:31]
    s_waitcnt lgkmcnt(1)
    v_mfma_f32_32x32x16_bf16 v[16:31], v[72:75], v[248:251], v[16:31]
    s_add_u32 m0, s72, 122880
    s_add_u32 s55, s71, 203776
    buffer_load_dwordx4 v7, s[4:7], s55 offen lds
    s_waitcnt lgkmcnt(0)
    v_mfma_f32_32x32x16_bf16 v[16:31], v[76:79], v[252:255], v[16:31]
    s_setprio 0
    s_barrier
    ds_read_b128 v[64:67], v12 offset:384
    ds_read_b128 v[68:71], v12 offset:416
    ds_read_b128 v[72:75], v12 offset:448
    ds_read_b128 v[76:79], v12 offset:480
    s_waitcnt lgkmcnt(3)
    s_nop 4
    v_fmac_f32 v16, v4, v64
    v_fmac_f32 v17, v4, v65
    v_fmac_f32 v18, v4, v66
    v_fmac_f32 v19, v4, v67
    v_mul_f32 v80, v16, v16
    v_mul_f32 v81, v17, v17
    v_mul_f32 v82, v18, v18
    v_mul_f32 v83, v19, v19
    s_waitcnt lgkmcnt(2)
    v_fmac_f32 v20, v4, v68
    v_fmac_f32 v21, v4, v69
    v_fmac_f32 v22, v4, v70
    v_fmac_f32 v23, v4, v71
    v_mul_f32 v84, v20, v20
    v_mul_f32 v85, v21, v21
    v_mul_f32 v86, v22, v22
    v_mul_f32 v87, v23, v23
    s_waitcnt lgkmcnt(1)
    v_fmac_f32 v24, v4, v72
    v_fmac_f32 v25, v4, v73
    v_fmac_f32 v26, v4, v74
    v_fmac_f32 v27, v4, v75
    s_waitcnt lgkmcnt(0)
    v_fmac_f32 v28, v4, v76
    v_fmac_f32 v29, v4, v77
    v_fmac_f32 v30, v4, v78
    v_fmac_f32 v31, v4, v79
    v_fma_f32 v80, v80, v113, v6
    v_fma_f32 v81, v81, v113, v6
    v_fma_f32 v82, v82, v113, v6
    v_fma_f32 v83, v83, v113, v6
    v_fma_f32 v84, v84, v113, v6
    v_fma_f32 v85, v85, v113, v6
    v_fma_f32 v86, v86, v113, v6
    v_fma_f32 v87, v87, v113, v6
    v_mul_f32 v80, v80, v16
    v_mul_f32 v81, v81, v17
    v_mul_f32 v82, v82, v18
    v_mul_f32 v83, v83, v19
    v_mul_f32 v84, v84, v20
    v_mul_f32 v85, v85, v21
    v_mul_f32 v86, v86, v22
    v_mul_f32 v87, v87, v23
    v_exp_f32 v80, v80
    v_mul_f32 v16, v16, v24
    v_exp_f32 v81, v81
    v_mul_f32 v17, v17, v25
    v_exp_f32 v82, v82
    v_mul_f32 v18, v18, v26
    v_exp_f32 v83, v83
    v_mul_f32 v19, v19, v27
    v_exp_f32 v84, v84
    v_mul_f32 v20, v20, v28
    v_exp_f32 v85, v85
    v_mul_f32 v21, v21, v29
    v_exp_f32 v86, v86
    v_mul_f32 v22, v22, v30
    v_exp_f32 v87, v87
    v_mul_f32 v23, v23, v31
    v_fma_f32 v80, v80, v114, v114
    v_fma_f32 v81, v81, v114, v114
    v_fma_f32 v82, v82, v114, v114
    v_fma_f32 v83, v83, v114, v114
    v_fma_f32 v84, v84, v114, v114
    v_fma_f32 v85, v85, v114, v114
    v_fma_f32 v86, v86, v114, v114
    v_fma_f32 v87, v87, v114, v114
    v_rcp_f32 v80, v80
    v_rcp_f32 v81, v81
    v_rcp_f32 v82, v82
    v_rcp_f32 v83, v83
    v_rcp_f32 v84, v84
    v_rcp_f32 v85, v85
    v_rcp_f32 v86, v86
    v_rcp_f32 v87, v87
    v_mul_f32 v16, v16, v80
    v_mul_f32 v17, v17, v81
    v_cvt_pk_bf16_f32 v88, v16, v17
    v_mul_f32 v18, v18, v82
    v_mul_f32 v19, v19, v83
    v_cvt_pk_bf16_f32 v89, v18, v19
    v_mul_f32 v20, v20, v84
    v_mul_f32 v21, v21, v85
    v_cvt_pk_bf16_f32 v90, v20, v21
    v_mul_f32 v22, v22, v86
    v_mul_f32 v23, v23, v87
    v_cvt_pk_bf16_f32 v91, v22, v23
    v_permlane32_swap_b32 v88, v90
    s_nop 0
    v_permlane32_swap_b32 v89, v91
    s_add_u32 s58, s78, 3072
    buffer_store_dwordx4 v[88:91], v7, s[4:7], s58 offen sc1
    s_and_b32 s16, s3, 1
    s_lshr_b32 s17, s3, 1
    s_mul_i32 s19, s17, 114688
    s_lshl_b32 s18, s53, 1
    s_add_u32 s18, s18, s16
    s_mul_i32 s18, s18, 112
    s_mul_i32 s55, s17, 7
    s_add_u32 s18, s18, s55
    s_lshl_b32 s18, s18, 10
    s_add_u32 s18, s18, 7340032
    v_and_b32 v14, 15, v0
    v_lshrrev_b32 v14, 2, v14
    v_lshrrev_b32 v15, 5, v0
    v_lshl_add_u32 v15, v15, 3, v14
    s_lshl_b32 s55, s17, 5
    v_add_u32 v15, s55, v15
    v_lshlrev_b32 v2, 7, v15
    v_bfe_u32 v14, v14, 1, 1
    v_lshlrev_b32 v14, 2, v14
    v_bfe_u32 v15, v0, 4, 1
    v_lshlrev_b32 v15, 1, v15
    v_bfe_u32 v8, v0, 1, 1
    v_add_u32 v15, v15, v8
    v_xor_b32 v9, v15, v14
    v_or_b32 v15, 4, v15
    v_xor_b32 v10, v15, v14
    v_and_b32 v8, 1, v0
    v_lshlrev_b32 v8, 3, v8
    v_add_u32 v2, v2, v8
    v_lshl_add_u32 v11, v10, 4, v2
    v_lshl_add_u32 v2, v9, 4, v2
    v_lshrrev_b32 v14, 3, v0
    v_and_b32 v15, 7, v0
    v_lshlrev_b32 v15, 4, v15
    v_lshl_add_u32 v13, v14, 12, v15
    s_waitcnt vmcnt(9)
    s_barrier
    v_add_u32 v3, 82944, v7
    s_setprio 1
    ds_read_b128 v[48:51], v3 offset:0
    ds_read_b128 v[52:55], v3 offset:1024
    ds_read_b128 v[56:59], v3 offset:2048
    ds_read_b128 v[60:63], v3 offset:3072
    ds_read_b128 v[64:67], v3 offset:4096
    ds_read_b128 v[68:71], v3 offset:5120
    ds_read_b128 v[72:75], v3 offset:6144
    s_waitcnt lgkmcnt(6)
    v_mfma_f32_32x32x16_bf16 v[16:31], v[48:51], v[128:131], 0
    ds_read_b128 v[76:79], v3 offset:7168
    s_waitcnt lgkmcnt(6)
    v_mfma_f32_32x32x16_bf16 v[16:31], v[52:55], v[132:135], v[16:31]
    s_add_u32 m0, s74, 49152
    s_add_u32 s55, s73, 917504
    buffer_load_dwordx4 v112, s[8:11], s55 offen lds
    ds_read_b128 v[48:51], v3 offset:8192
    s_waitcnt lgkmcnt(6)
    v_mfma_f32_32x32x16_bf16 v[16:31], v[56:59], v[136:139], v[16:31]
    ds_read_b128 v[52:55], v3 offset:9216
    s_waitcnt lgkmcnt(6)
    v_mfma_f32_32x32x16_bf16 v[16:31], v[60:63], v[140:143], v[16:31]
    ds_read_b128 v[56:59], v3 offset:10240
    s_waitcnt lgkmcnt(6)
    v_mfma_f32_32x32x16_bf16 v[16:31], v[64:67], v[144:147], v[16:31]
    ds_read_b128 v[60:63], v3 offset:11264
    s_waitcnt lgkmcnt(6)
    v_mfma_f32_32x32x16_bf16 v[16:31], v[68:71], v[148:151], v[16:31]
    s_add_u32 m0, s74, 50176
    s_add_u32 s55, s73, 925696
    buffer_load_dwordx4 v112, s[8:11], s55 offen lds
    ds_read_b128 v[64:67], v3 offset:12288
    s_waitcnt lgkmcnt(6)
    v_mfma_f32_32x32x16_bf16 v[16:31], v[72:75], v[152:155], v[16:31]
    ds_read_b128 v[68:71], v3 offset:13312
    s_waitcnt lgkmcnt(6)
    v_mfma_f32_32x32x16_bf16 v[16:31], v[76:79], v[156:159], v[16:31]
    ds_read_b128 v[72:75], v3 offset:14336
    s_waitcnt lgkmcnt(6)
    v_mfma_f32_32x32x16_bf16 v[16:31], v[48:51], v[160:163], v[16:31]
    ds_read_b128 v[76:79], v3 offset:15360
    s_waitcnt lgkmcnt(6)
    v_mfma_f32_32x32x16_bf16 v[16:31], v[52:55], v[164:167], v[16:31]
    s_add_u32 m0, s74, 51200
    s_add_u32 s55, s73, 933888
    buffer_load_dwordx4 v112, s[8:11], s55 offen lds
    ds_read_b128 v[48:51], v3 offset:16384
    s_waitcnt lgkmcnt(6)
    v_mfma_f32_32x32x16_bf16 v[16:31], v[56:59], v[168:171], v[16:31]
    ds_read_b128 v[52:55], v3 offset:17408
    s_waitcnt lgkmcnt(6)
    v_mfma_f32_32x32x16_bf16 v[16:31], v[60:63], v[172:175], v[16:31]
    ds_read_b128 v[56:59], v3 offset:18432
    s_waitcnt lgkmcnt(6)
    v_mfma_f32_32x32x16_bf16 v[16:31], v[64:67], v[176:179], v[16:31]
    ds_read_b128 v[60:63], v3 offset:19456
    s_waitcnt lgkmcnt(6)
    v_mfma_f32_32x32x16_bf16 v[16:31], v[68:71], v[180:183], v[16:31]
    s_add_u32 m0, s74, 52224
    s_add_u32 s55, s73, 942080
    buffer_load_dwordx4 v112, s[8:11], s55 offen lds
    ds_read_b128 v[64:67], v3 offset:20480
    s_waitcnt lgkmcnt(6)
    v_mfma_f32_32x32x16_bf16 v[16:31], v[72:75], v[184:187], v[16:31]
    ds_read_b128 v[68:71], v3 offset:21504
    s_waitcnt lgkmcnt(6)
    v_mfma_f32_32x32x16_bf16 v[16:31], v[76:79], v[188:191], v[16:31]
    ds_read_b128 v[72:75], v3 offset:22528
    s_waitcnt lgkmcnt(6)
    v_mfma_f32_32x32x16_bf16 v[16:31], v[48:51], v[192:195], v[16:31]
    ds_read_b128 v[76:79], v3 offset:23552
    s_waitcnt lgkmcnt(6)
    v_mfma_f32_32x32x16_bf16 v[16:31], v[52:55], v[196:199], v[16:31]
    s_add_u32 m0, s74, 65536
    s_add_u32 s55, s73, 950272
    buffer_load_dwordx4 v112, s[8:11], s55 offen lds
    ds_read_b128 v[48:51], v3 offset:24576
    s_waitcnt lgkmcnt(6)
    v_mfma_f32_32x32x16_bf16 v[16:31], v[56:59], v[200:203], v[16:31]
    ds_read_b128 v[52:55], v3 offset:25600
    s_waitcnt lgkmcnt(6)
    v_mfma_f32_32x32x16_bf16 v[16:31], v[60:63], v[204:207], v[16:31]
    ds_read_b128 v[56:59], v3 offset:26624
    s_waitcnt lgkmcnt(6)
    v_mfma_f32_32x32x16_bf16 v[16:31], v[64:67], v[208:211], v[16:31]
    ds_read_b128 v[60:63], v3 offset:27648
    s_waitcnt lgkmcnt(6)
    v_mfma_f32_32x32x16_bf16 v[16:31], v[68:71], v[212:215], v[16:31]
    s_add_u32 m0, s74, 66560
    s_add_u32 s55, s73, 958464
    buffer_load_dwordx4 v112, s[8:11], s55 offen lds
    ds_read_b128 v[64:67], v3 offset:28672
    s_waitcnt lgkmcnt(6)
    v_mfma_f32_32x32x16_bf16 v[16:31], v[72:75], v[216:219], v[16:31]
    ds_read_b128 v[68:71], v3 offset:29696
    s_waitcnt lgkmcnt(6)
    v_mfma_f32_32x32x16_bf16 v[16:31], v[76:79], v[220:223], v[16:31]
    ds_read_b128 v[72:75], v3 offset:30720
    s_waitcnt lgkmcnt(6)
    v_mfma_f32_32x32x16_bf16 v[16:31], v[48:51], v[224:227], v[16:31]
    ds_read_b128 v[76:79], v3 offset:31744
    s_waitcnt lgkmcnt(6)
    v_mfma_f32_32x32x16_bf16 v[16:31], v[52:55], v[228:231], v[16:31]
    s_add_u32 m0, s74, 67584
    s_add_u32 s55, s73, 1376256
    buffer_load_dwordx4 v112, s[8:11], s55 offen lds
    s_waitcnt lgkmcnt(5)
    v_mfma_f32_32x32x16_bf16 v[16:31], v[56:59], v[232:235], v[16:31]
    s_waitcnt lgkmcnt(4)
    v_mfma_f32_32x32x16_bf16 v[16:31], v[60:63], v[236:239], v[16:31]
    s_waitcnt lgkmcnt(3)
    v_mfma_f32_32x32x16_bf16 v[16:31], v[64:67], v[240:243], v[16:31]
    s_waitcnt lgkmcnt(2)
    v_mfma_f32_32x32x16_bf16 v[16:31], v[68:71], v[244:247], v[16:31]
    s_waitcnt lgkmcnt(1)
    v_mfma_f32_32x32x16_bf16 v[16:31], v[72:75], v[248:251], v[16:31]
    s_add_u32 m0, s74, 68608
    s_add_u32 s55, s73, 1384448
    buffer_load_dwordx4 v112, s[8:11], s55 offen lds
    s_waitcnt lgkmcnt(0)
    v_mfma_f32_32x32x16_bf16 v[16:31], v[76:79], v[252:255], v[16:31]
    s_setprio 0
    s_waitcnt vmcnt(9)
    s_barrier
    s_lshr_b32 s60, s53, 1
    s_lshl_b32 s60, s60, 8
    s_add_u32 s60, s60, 274432
    s_cmp_eq_u32 s3, 7
    s_cbranch_scc0 L_p7a_41
    v_mov_b32 v116, 0
    buffer_load_dword v117, v116, s[4:7], s60 offen sc1
L_p7a_41:
    ds_read_b128 v[64:67], v12 offset:640
    ds_read_b128 v[68:71], v12 offset:672
    ds_read_b128 v[72:75], v12 offset:704
    ds_read_b128 v[76:79], v12 offset:736
    s_waitcnt lgkmcnt(3)
    v_fmac_f32 v16, v4, v64
    v_fmac_f32 v17, v4, v65
    v_fmac_f32 v18, v4, v66
    v_fmac_f32 v19, v4, v67
    v_mul_f32 v80, v16, v16
    v_mul_f32 v81, v17, v17
    v_mul_f32 v82, v18, v18
    v_mul_f32 v83, v19, v19
    s_waitcnt lgkmcnt(2)
    v_fmac_f32 v20, v4, v68
    v_fmac_f32 v21, v4, v69
    v_fmac_f32 v22, v4, v70
    v_fmac_f32 v23, v4, v71
    v_mul_f32 v84, v20, v20
    v_mul_f32 v85, v21, v21
    v_mul_f32 v86, v22, v22
    v_mul_f32 v87, v23, v23
    s_waitcnt lgkmcnt(1)
    v_fmac_f32 v24, v4, v72
    v_fmac_f32 v25, v4, v73
    v_fmac_f32 v26, v4, v74
    v_fmac_f32 v27, v4, v75
    s_waitcnt lgkmcnt(0)
    v_fmac_f32 v28, v4, v76
    v_fmac_f32 v29, v4, v77
    v_fmac_f32 v30, v4, v78
    v_fmac_f32 v31, v4, v79
    v_fma_f32 v80, v80, v113, v6
    v_fma_f32 v81, v81, v113, v6
    v_fma_f32 v82, v82, v113, v6
    v_fma_f32 v83, v83, v113, v6
    v_fma_f32 v84, v84, v113, v6
    v_fma_f32 v85, v85, v113, v6
    v_fma_f32 v86, v86, v113, v6
    v_fma_f32 v87, v87, v113, v6
    v_mul_f32 v80, v80, v16
    v_mul_f32 v81, v81, v17
    v_mul_f32 v82, v82, v18
    v_mul_f32 v83, v83, v19
    v_mul_f32 v84, v84, v20
    v_mul_f32 v85, v85, v21
    v_mul_f32 v86, v86, v22
    v_mul_f32 v87, v87, v23
    v_exp_f32 v80, v80
    v_mul_f32 v16, v16, v24
    v_exp_f32 v81, v81
    v_mul_f32 v17, v17, v25
    v_exp_f32 v82, v82
    v_mul_f32 v18, v18, v26
    v_exp_f32 v83, v83
    v_mul_f32 v19, v19, v27
    v_exp_f32 v84, v84
    v_mul_f32 v20, v20, v28
    v_exp_f32 v85, v85
    v_mul_f32 v21, v21, v29
    v_exp_f32 v86, v86
    v_mul_f32 v22, v22, v30
    v_exp_f32 v87, v87
    v_mul_f32 v23, v23, v31
    v_fma_f32 v80, v80, v114, v114
    v_fma_f32 v81, v81, v114, v114
    v_fma_f32 v82, v82, v114, v114
    v_fma_f32 v83, v83, v114, v114
    v_fma_f32 v84, v84, v114, v114
    v_fma_f32 v85, v85, v114, v114
    v_fma_f32 v86, v86, v114, v114
    v_fma_f32 v87, v87, v114, v114
    v_rcp_f32 v80, v80
    v_rcp_f32 v81, v81
    v_rcp_f32 v82, v82
    v_rcp_f32 v83, v83
    v_rcp_f32 v84, v84
    v_rcp_f32 v85, v85
    v_rcp_f32 v86, v86
    v_rcp_f32 v87, v87
    v_mul_f32 v16, v16, v80
    v_mul_f32 v17, v17, v81
    v_cvt_pk_bf16_f32 v88, v16, v17
    v_mul_f32 v18, v18, v82
    v_mul_f32 v19, v19, v83
    v_cvt_pk_bf16_f32 v89, v18, v19
    v_mul_f32 v20, v20, v84
    v_mul_f32 v21, v21, v85
    v_cvt_pk_bf16_f32 v90, v20, v21
    v_mul_f32 v22, v22, v86
    v_mul_f32 v23, v23, v87
    v_cvt_pk_bf16_f32 v91, v22, v23
    v_permlane32_swap_b32 v88, v90
    s_nop 0
    v_permlane32_swap_b32 v89, v91
    s_add_u32 s58, s78, 5120
    buffer_store_dwordx4 v[88:91], v7, s[4:7], s58 offen sc1
    s_cmp_eq_u32 s3, 7
    s_cbranch_scc0 L_p7b_42
    s_waitcnt vmcnt(1)
    v_cmp_gt_u32 vcc, 16, v117
    s_nop 1
    s_cbranch_vccz L_p7b_42
    v_min_u32 v116, 0, v0
    s_mov_b32 s55, 256
    v_mul_lo_u32 v116, v116, s55
    s_mov_b32 s56, s60
    s_mov_b32 s83, 0
L_poll_b3a_43:
    buffer_load_dword v117, v116, s[4:7], s56 offen sc1
    s_add_u32 s83, s83, 1
    s_waitcnt vmcnt(0)
    v_cmp_gt_u32 vcc, 16, v117
    s_cmp_ge_u32 s83, 30000
    s_cbranch_scc1 L_polld_b3a_44
    s_cbranch_vccz L_polld_b3a_44
    s_sleep 1
    s_branch L_poll_b3a_43
L_polld_b3a_44:
L_p7b_42:
    s_waitcnt vmcnt(9)
    s_barrier
    s_cmp_eq_u32 s3, 4
    s_cbranch_scc0 L_arr3b_45
    s_lshl_b32 s56, s51, 8
    s_add_u32 s56, s56, 278528
    v_mov_b32 v14, 1
    v_mov_b32 v15, 0
    s_mov_b64 s[90:91], exec
    s_mov_b64 exec, 1
    buffer_atomic_add v14, v15, s[4:7], s56 offen
    s_mov_b64 exec, s[90:91]
L_arr3b_45:
    s_add_u32 s55, s18, 0
    buffer_load_dwordx4 v[128:131], v7, s[4:7], s55 offen
    s_add_u32 s55, s18, 1024
    buffer_load_dwordx4 v[132:135], v7, s[4:7], s55 offen
    s_add_u32 s55, s18, 2048
    buffer_load_dwordx4 v[136:139], v7, s[4:7], s55 offen
    s_add_u32 s55, s18, 28672
    buffer_load_dwordx4 v[140:143], v7, s[4:7], s55 offen
    s_add_u32 s55, s18, 29696
    buffer_load_dwordx4 v[144:147], v7, s[4:7], s55 offen
    s_add_u32 s55, s18, 30720
    buffer_load_dwordx4 v[148:151], v7, s[4:7], s55 offen
    s_add_u32 s55, s18, 57344
    buffer_load_dwordx4 v[152:155], v7, s[4:7], s55 offen
    s_add_u32 s55, s18, 58368
    buffer_load_dwordx4 v[156:159], v7, s[4:7], s55 offen
    s_add_u32 s55, s18, 59392
    buffer_load_dwordx4 v[160:163], v7, s[4:7], s55 offen
    s_add_u32 s55, s18, 86016
    buffer_load_dwordx4 v[164:167], v7, s[4:7], s55 offen
    s_add_u32 s55, s18, 87040
    buffer_load_dwordx4 v[168:171], v7, s[4:7], s55 offen
    s_add_u32 s55, s18, 88064
    buffer_load_dwordx4 v[172:175], v7, s[4:7], s55 offen
L_join_39:
    s_waitcnt vmcnt(12)
    s_barrier
    s_cmp_eq_u32 s3, 0
    s_cbranch_scc0 L_b3_46
    s_lshl_b32 s56, s51, 8
    s_add_u32 s56, s56, 270336
    v_mov_b32 v14, 1
    v_mov_b32 v15, 0
    s_mov_b64 s[90:91], exec
    s_mov_b64 exec, 1
    buffer_atomic_add v14, v15, s[4:7], s56 offen
    s_mov_b64 exec, s[90:91]
L_b3_46:
    s_bitcmp1_b32 s3, 0
    s_mov_b32 s55, 507904
    s_cselect_b32 s55, 524288, s55
    s_add_u32 s55, s55, s19
    s_lshl_b32 s56, s3, 11
    s_add_u32 m0, s56, 114688
    s_nop 0
    buffer_load_dwordx4 v112, s[8:11], s55 offen lds
    s_add_u32 m0, m0, 1024
    s_add_u32 s55, s55, 8192
    buffer_load_dwordx4 v112, s[8:11], s55 offen lds
    s_bitcmp1_b32 s3, 0
    s_mov_b32 s55, 966656
    s_cselect_b32 s55, 983040, s55
    s_add_u32 s55, s55, s19
    s_lshl_b32 s56, s3, 11
    s_add_u32 m0, s56, 131072
    s_nop 0
    buffer_load_dwordx4 v112, s[8:11], s55 offen lds
    s_add_u32 m0, m0, 1024
    s_add_u32 s55, s55, 8192
    buffer_load_dwordx4 v112, s[8:11], s55 offen lds
    s_lshl_b32 s55, s54, 6
    s_lshl_b32 s56, s3, 3
    s_add_u32 s55, s55, s56
    s_lshl_b32 s55, s55, 12
    s_lshl_b32 s56, s53, 7
    s_add_u32 s55, s55, s56
    s_add_u32 s55, s55, 1048576
    s_lshl_b32 s56, s3, 10
    s_add_u32 m0, s56, 147456
    s_nop 0
    buffer_load_dwordx4 v13, s[4:7], s55 offen lds
    s_cmp_eq_u32 s3, 7
    s_cbranch_scc0 L_look_47
    s_lshr_b32 s60, s53, 1
    s_lshl_b32 s60, s60, 8
    s_add_u32 s60, s60, 278528
    v_mov_b32 v80, 0
    buffer_load_dword v81, v80, s[4:7], s60 offen sc1
L_look_47:
    v_add_u32 v12, 0, v2
    v_add_u32 v13, 0, v11
    ds_read_b64_tr_b16 v[48:49], v12 offset:0
    ds_read_b64_tr_b16 v[50:51], v12 offset:512
    ds_read_b64_tr_b16 v[52:53], v13 offset:0
    ds_read_b64_tr_b16 v[54:55], v13 offset:512
    ds_read_b64_tr_b16 v[56:57], v12 offset:2048
    ds_read_b64_tr_b16 v[58:59], v12 offset:2560
    ds_read_b64_tr_b16 v[60:61], v13 offset:2048
    ds_read_b64_tr_b16 v[62:63], v13 offset:2560
    s_waitcnt vmcnt(15)
    v_add_u32 v12, 16384, v2
    v_add_u32 v13, 16384, v11
    s_waitcnt lgkmcnt(0)
    v_mfma_f32_32x32x16_bf16 v[16:31], v[48:51], v[128:131], 0
    ds_read_b64_tr_b16 v[64:65], v12 offset:0
    ds_read_b64_tr_b16 v[66:67], v12 offset:512
    ds_read_b64_tr_b16 v[68:69], v13 offset:0
    ds_read_b64_tr_b16 v[70:71], v13 offset:512
    v_mfma_f32_32x32x16_bf16 v[32:47], v[52:55], v[128:131], 0
    ds_read_b64_tr_b16 v[72:73], v12 offset:2048
    ds_read_b64_tr_b16 v[74:75], v12 offset:2560
    ds_read_b64_tr_b16 v[76:77], v13 offset:2048
    ds_read_b64_tr_b16 v[78:79], v13 offset:2560
    v_mfma_f32_32x32x16_bf16 v[16:31], v[56:59], v[132:135], v[16:31]
    v_mfma_f32_32x32x16_bf16 v[32:47], v[60:63], v[132:135], v[32:47]
    s_lshl_b32 s55, s16, 2
    s_add_u32 s55, s55, s17
    s_lshl_b32 s55, s55, 13
    s_add_u32 s55, s55, 81920
    v_add_u32 v92, s55, v7
    s_add_u32 s55, s17, 1
    s_and_b32 s55, s55, 3
    s_lshl_b32 s55, s55, 13
    s_lshl_b32 s56, s16, 15
    s_add_u32 s55, s55, s56
    s_lshl_b32 s56, s17, 11
    s_add_u32 s55, s55, s56
    s_add_u32 s55, s55, 81920
    v_add_u32 v93, s55, v7
    s_add_u32 s55, s17, 2
    s_and_b32 s55, s55, 3
    s_lshl_b32 s55, s55, 13
    s_lshl_b32 s56, s16, 15
    s_add_u32 s55, s55, s56
    s_lshl_b32 s56, s17, 11
    s_add_u32 s55, s55, s56
    s_add_u32 s55, s55, 81920
    v_add_u32 v94, s55, v7
    s_add_u32 s55, s17, 3
    s_and_b32 s55, s55, 3
    s_lshl_b32 s55, s55, 13
    s_lshl_b32 s56, s16, 15
    s_add_u32 s55, s55, s56
    s_lshl_b32 s56, s17, 11
    s_add_u32 s55, s55, s56
    s_add_u32 s55, s55, 81920
    v_add_u32 v95, s55, v7
    v_and_b32 v15, 15, v0
    v_lshrrev_b32 v8, 2, v15
    v_lshrrev_b32 v9, 5, v0
    v_lshl_add_u32 v8, v9, 2, v8
    s_lshl_b32 s55, s17, 4
    v_add_u32 v8, s55, v8
    v_lshlrev_b32 v8, 7, v8
    v_bfe_u32 v9, v0, 4, 1
    v_lshlrev_b32 v9, 5, v9
    v_add_u32 v8, v8, v9
    v_and_b32 v9, 3, v0
    v_lshl_add_u32 v8, v9, 3, v8
    s_lshl_b32 s55, s16, 6
    s_add_u32 s55, s55, 147456
    v_add_u32 v96, s55, v8
    s_mov_b32 s12, s42
    s_mov_b32 s13, s43
    s_mov_b32 s14, 2097152
    s_mov_b32 s15, 0x20000
    v_and_b32 v9, 31, v0
    v_lshlrev_b32 v9, 10, v9
    v_lshrrev_b32 v10, 5, v0
    v_lshl_add_u32 v97, v10, 4, v9
    s_lshl_b32 s57, s53, 1
    s_add_u32 s57, s57, s16
    s_lshl_b32 s57, s57, 15
    s_lshl_b32 s56, s54, 7
    s_add_u32 s57, s57, s56
    s_lshl_b32 s56, s17, 5
    s_add_u32 s57, s57, s56
    s_waitcnt vmcnt(13)
    v_add_u32 v12, 32768, v2
    v_add_u32 v13, 32768, v11
    s_waitcnt lgkmcnt(0)
    v_mfma_f32_32x32x16_bf16 v[16:31], v[64:67], v[136:139], v[16:31]
    ds_read_b64_tr_b16 v[48:49], v12 offset:0
    ds_read_b64_tr_b16 v[50:51], v12 offset:512
    ds_read_b64_tr_b16 v[52:53], v13 offset:0
    ds_read_b64_tr_b16 v[54:55], v13 offset:512
    v_mfma_f32_32x32x16_bf16 v[32:47], v[68:71], v[136:139], v[32:47]
    ds_read_b64_tr_b16 v[56:57], v12 offset:2048
    ds_read_b64_tr_b16 v[58:59], v12 offset:2560
    ds_read_b64_tr_b16 v[60:61], v13 offset:2048
    ds_read_b64_tr_b16 v[62:63], v13 offset:2560
    v_mfma_f32_32x32x16_bf16 v[16:31], v[72:75], v[140:143], v[16:31]
    v_mfma_f32_32x32x16_bf16 v[32:47], v[76:79], v[140:143], v[32:47]
    s_cmp_eq_u32 s3, 7
    s_cbranch_scc0 L_p4poll_48
    s_waitcnt vmcnt(0)
    v_cmp_gt_u32 vcc, 16, v81
    s_nop 1
    s_cbranch_vccz L_p4poll_48
    s_lshr_b32 s60, s53, 1
    s_lshl_b32 s60, s60, 8
    s_add_u32 s60, s60, 278528
    v_min_u32 v83, 0, v0
    s_mov_b32 s55, 256
    v_mul_lo_u32 v83, v83, s55
    s_mov_b32 s56, s60
    s_mov_b32 s83, 0
L_poll_b3_49:
    buffer_load_dword v82, v83, s[4:7], s56 offen sc1
    s_add_u32 s83, s83, 1
    s_waitcnt vmcnt(0)
    v_cmp_gt_u32 vcc, 16, v82
    s_cmp_ge_u32 s83, 30000
    s_cbranch_scc1 L_polld_b3_50
    s_cbranch_vccz L_polld_b3_50
    s_sleep 1
    s_branch L_poll_b3_49
L_polld_b3_50:
L_p4poll_48:
    s_barrier
    s_waitcnt vmcnt(11)
    v_add_u32 v12, 49152, v2
    v_add_u32 v13, 49152, v11
    s_waitcnt lgkmcnt(0)
    v_mfma_f32_32x32x16_bf16 v[16:31], v[48:51], v[144:147], v[16:31]
    ds_read_b64_tr_b16 v[64:65], v12 offset:0
    ds_read_b64_tr_b16 v[66:67], v12 offset:512
    ds_read_b64_tr_b16 v[68:69], v13 offset:0
    ds_read_b64_tr_b16 v[70:71], v13 offset:512
    v_mfma_f32_32x32x16_bf16 v[32:47], v[52:55], v[144:147], v[32:47]
    ds_read_b64_tr_b16 v[72:73], v12 offset:2048
    ds_read_b64_tr_b16 v[74:75], v12 offset:2560
    ds_read_b64_tr_b16 v[76:77], v13 offset:2048
    ds_read_b64_tr_b16 v[78:79], v13 offset:2560
    v_mfma_f32_32x32x16_bf16 v[16:31], v[56:59], v[148:151], v[16:31]
    s_add_u32 s55, s18, 3072
    buffer_load_dwordx4 v[176:179], v7, s[4:7], s55 offen
    s_add_u32 s55, s18, 4096
    buffer_load_dwordx4 v[180:183], v7, s[4:7], s55 offen
    v_mfma_f32_32x32x16_bf16 v[32:47], v[60:63], v[148:151], v[32:47]
    s_add_u32 s55, s18, 31744
    buffer_load_dwordx4 v[184:187], v7, s[4:7], s55 offen
    s_waitcnt vmcnt(12)
    v_add_u32 v12, 65536, v2
    v_add_u32 v13, 65536, v11
    s_waitcnt lgkmcnt(0)
    v_mfma_f32_32x32x16_bf16 v[16:31], v[64:67], v[152:155], v[16:31]
    ds_read_b64_tr_b16 v[48:49], v12 offset:0
    ds_read_b64_tr_b16 v[50:51], v12 offset:512
    ds_read_b64_tr_b16 v[52:53], v13 offset:0
    ds_read_b64_tr_b16 v[54:55], v13 offset:512
    v_mfma_f32_32x32x16_bf16 v[32:47], v[68:71], v[152:155], v[32:47]
    ds_read_b64_tr_b16 v[56:57], v12 offset:2048
    ds_read_b64_tr_b16 v[58:59], v12 offset:2560
    ds_read_b64_tr_b16 v[60:61], v13 offset:2048
    ds_read_b64_tr_b16 v[62:63], v13 offset:2560
    v_mfma_f32_32x32x16_bf16 v[16:31], v[72:75], v[156:159], v[16:31]
    s_add_u32 s55, s18, 32768
    buffer_load_dwordx4 v[188:191], v7, s[4:7], s55 offen
    s_add_u32 s55, s18, 60416
    buffer_load_dwordx4 v[192:195], v7, s[4:7], s55 offen
    v_mfma_f32_32x32x16_bf16 v[32:47], v[76:79], v[156:159], v[32:47]
    s_add_u32 s55, s18, 61440
    buffer_load_dwordx4 v[196:199], v7, s[4:7], s55 offen
    s_bitcmp1_b32 s3, 0
    s_mov_b32 s55, 1425408
    s_cselect_b32 s55, 1441792, s55
    s_add_u32 s55, s55, s19
    s_lshl_b32 s56, s3, 11
    s_add_u32 m0, s56, 0
    s_nop 0
    buffer_load_dwordx4 v112, s[8:11], s55 offen lds
    s_add_u32 m0, m0, 1024
    s_add_u32 s55, s55, 8192
    buffer_load_dwordx4 v112, s[8:11], s55 offen lds
    s_bitcmp1_b32 s3, 0
    s_mov_b32 s55, 81920
    s_cselect_b32 s55, 98304, s55
    s_add_u32 s55, s55, s19
    s_lshl_b32 s56, s3, 11
    s_add_u32 m0, s56, 16384
    s_nop 0
    buffer_load_dwordx4 v112, s[8:11], s55 offen lds
    s_add_u32 m0, m0, 1024
    s_add_u32 s55, s55, 8192
    buffer_load_dwordx4 v112, s[8:11], s55 offen lds
    s_waitcnt vmcnt(17)
    v_add_u32 v12, 81920, v2
    v_add_u32 v13, 81920, v11
    s_waitcnt lgkmcnt(0)
    v_mfma_f32_32x32x16_bf16 v[16:31], v[48:51], v[160:163], v[16:31]
    ds_read_b64_tr_b16 v[64:65], v12 offset:0
    ds_read_b64_tr_b16 v[66:67], v12 offset:512
    ds_read_b64_tr_b16 v[68:69], v13 offset:0
    ds_read_b64_tr_b16 v[70:71], v13 offset:512
    v_mfma_f32_32x32x16_bf16 v[32:47], v[52:55], v[160:163], v[32:47]
    ds_read_b64_tr_b16 v[72:73], v12 offset:2048
    ds_read_b64_tr_b16 v[74:75], v12 offset:2560
    ds_read_b64_tr_b16 v[76:77], v13 offset:2048
    ds_read_b64_tr_b16 v[78:79], v13 offset:2560
    v_mfma_f32_32x32x16_bf16 v[16:31], v[56:59], v[164:167], v[16:31]
    s_add_u32 s55, s18, 89088
    buffer_load_dwordx4 v[200:203], v7, s[4:7], s55 offen
    v_mfma_f32_32x32x16_bf16 v[32:47], v[60:63], v[164:167], v[32:47]
    s_add_u32 s55, s18, 90112
    buffer_load_dwordx4 v[204:207], v7, s[4:7], s55 offen
    s_cmp_eq_u32 s3, 6
    s_cbranch_scc0 L_look_51
    s_lshr_b32 s60, s53, 1
    s_lshl_b32 s60, s60, 8
    s_add_u32 s60, s60, 270336
    v_mov_b32 v80, 0
    buffer_load_dword v81, v80, s[4:7], s60 offen sc1
L_look_51:
    s_waitcnt vmcnt(17)
    v_add_u32 v12, 98304, v2
    v_add_u32 v13, 98304, v11
    s_waitcnt lgkmcnt(0)
    v_mfma_f32_32x32x16_bf16 v[16:31], v[64:67], v[168:171], v[16:31]
    ds_read_b64_tr_b16 v[48:49], v12 offset:0
    ds_read_b64_tr_b16 v[50:51], v12 offset:512
    ds_read_b64_tr_b16 v[52:53], v13 offset:0
    ds_read_b64_tr_b16 v[54:55], v13 offset:512
    v_mfma_f32_32x32x16_bf16 v[32:47], v[68:71], v[168:171], v[32:47]
    ds_read_b64_tr_b16 v[56:57], v12 offset:2048
    ds_read_b64_tr_b16 v[58:59], v12 offset:2560
    ds_read_b64_tr_b16 v[60:61], v13 offset:2048
    ds_read_b64_tr_b16 v[62:63], v13 offset:2560
    v_mfma_f32_32x32x16_bf16 v[16:31], v[72:75], v[172:175], v[16:31]
    v_mfma_f32_32x32x16_bf16 v[32:47], v[76:79], v[172:175], v[32:47]
    s_waitcnt vmcnt(13)
    s_cmp_eq_u32 s3, 6
    s_cbranch_scc0 L_p4poll_52
    s_waitcnt vmcnt(0)
    v_cmp_gt_u32 vcc, 16, v81
    s_nop 1
    s_cbranch_vccz L_p4poll_52
    s_lshr_b32 s60, s53, 1
    s_lshl_b32 s60, s60, 8
    s_add_u32 s60, s60, 270336
    v_min_u32 v83, 0, v0
    s_mov_b32 s55, 256
    v_mul_lo_u32 v83, v83, s55
    s_mov_b32 s56, s60
    s_mov_b32 s83, 0
L_poll_b3_53:
    buffer_load_dword v82, v83, s[4:7], s56 offen sc1
    s_add_u32 s83, s83, 1
    s_waitcnt vmcnt(0)
    v_cmp_gt_u32 vcc, 16, v82
    s_cmp_ge_u32 s83, 30000
    s_cbranch_scc1 L_polld_b3_54
    s_cbranch_vccz L_polld_b3_54
    s_sleep 1
    s_branch L_poll_b3_53
L_polld_b3_54:
L_p4poll_52:
    s_barrier
    s_waitcnt vmcnt(10)
    v_add_u32 v12, 114688, v2
    v_add_u32 v13, 114688, v11
    s_waitcnt lgkmcnt(0)
    v_mfma_f32_32x32x16_bf16 v[16:31], v[48:51], v[176:179], v[16:31]
    ds_read_b64_tr_b16 v[64:65], v12 offset:0
    ds_read_b64_tr_b16 v[66:67], v12 offset:512
    ds_read_b64_tr_b16 v[68:69], v13 offset:0
    ds_read_b64_tr_b16 v[70:71], v13 offset:512
    v_mfma_f32_32x32x16_bf16 v[32:47], v[52:55], v[176:179], v[32:47]
    ds_read_b64_tr_b16 v[72:73], v12 offset:2048
    ds_read_b64_tr_b16 v[74:75], v12 offset:2560
    ds_read_b64_tr_b16 v[76:77], v13 offset:2048
    ds_read_b64_tr_b16 v[78:79], v13 offset:2560
    v_mfma_f32_32x32x16_bf16 v[16:31], v[56:59], v[180:183], v[16:31]
    s_add_u32 s55, s18, 5120
    buffer_load_dwordx4 v[208:211], v7, s[4:7], s55 offen
    s_add_u32 s55, s18, 6144
    buffer_load_dwordx4 v[212:215], v7, s[4:7], s55 offen
    v_mfma_f32_32x32x16_bf16 v[32:47], v[60:63], v[180:183], v[32:47]
    s_add_u32 s55, s18, 33792
    buffer_load_dwordx4 v[216:219], v7, s[4:7], s55 offen
    s_add_u32 s55, s18, 34816
    buffer_load_dwordx4 v[220:223], v7, s[4:7], s55 offen
    s_waitcnt vmcnt(12)
    v_add_u32 v12, 131072, v2
    v_add_u32 v13, 131072, v11
    s_waitcnt lgkmcnt(0)
    v_mfma_f32_32x32x16_bf16 v[16:31], v[64:67], v[184:187], v[16:31]
    ds_read_b64_tr_b16 v[48:49], v12 offset:0
    ds_read_b64_tr_b16 v[50:51], v12 offset:512
    ds_read_b64_tr_b16 v[52:53], v13 offset:0
    ds_read_b64_tr_b16 v[54:55], v13 offset:512
    v_mfma_f32_32x32x16_bf16 v[32:47], v[68:71], v[184:187], v[32:47]
    ds_read_b64_tr_b16 v[56:57], v12 offset:2048
    ds_read_b64_tr_b16 v[58:59], v12 offset:2560
    ds_read_b64_tr_b16 v[60:61], v13 offset:2048
    ds_read_b64_tr_b16 v[62:63], v13 offset:2560
    v_mfma_f32_32x32x16_bf16 v[16:31], v[72:75], v[188:191], v[16:31]
    s_add_u32 s55, s18, 62464
    buffer_load_dwordx4 v[224:227], v7, s[4:7], s55 offen
    s_add_u32 s55, s18, 63488
    buffer_load_dwordx4 v[228:231], v7, s[4:7], s55 offen
    v_mfma_f32_32x32x16_bf16 v[32:47], v[76:79], v[188:191], v[32:47]
    s_add_u32 s55, s18, 91136
    buffer_load_dwordx4 v[232:235], v7, s[4:7], s55 offen
    s_add_u32 s55, s18, 92160
    buffer_load_dwordx4 v[236:239], v7, s[4:7], s55 offen
    s_bitcmp1_b32 s3, 0
    s_mov_b32 s55, 540672
    s_cselect_b32 s55, 557056, s55
    s_add_u32 s55, s55, s19
    s_lshl_b32 s56, s3, 11
    s_add_u32 m0, s56, 32768
    s_nop 0
    buffer_load_dwordx4 v112, s[8:11], s55 offen lds
    s_add_u32 m0, m0, 1024
    s_add_u32 s55, s55, 8192
    buffer_load_dwordx4 v112, s[8:11], s55 offen lds
    s_bitcmp1_b32 s3, 0
    s_mov_b32 s55, 999424
    s_cselect_b32 s55, 1015808, s55
    s_add_u32 s55, s55, s19
    s_lshl_b32 s56, s3, 11
    s_add_u32 m0, s56, 49152
    s_nop 0
    buffer_load_dwordx4 v112, s[8:11], s55 offen lds
    s_add_u32 m0, m0, 1024
    s_add_u32 s55, s55, 8192
    buffer_load_dwordx4 v112, s[8:11], s55 offen lds
    s_bitcmp1_b32 s3, 0
    s_mov_b32 s55, 1458176
    s_cselect_b32 s55, 1474560, s55
    s_add_u32 s55, s55, s19
    s_lshl_b32 s56, s3, 11
    s_add_u32 m0, s56, 65536
    s_nop 0
    buffer_load_dwordx4 v112, s[8:11], s55 offen lds
    s_add_u32 m0, m0, 1024
    s_add_u32 s55, s55, 8192
    buffer_load_dwordx4 v112, s[8:11], s55 offen lds
    s_waitcnt vmcnt(16)
    s_barrier
    v_add_u32 v12, 0, v2
    v_add_u32 v13, 0, v11
    s_waitcnt lgkmcnt(0)
    v_mfma_f32_32x32x16_bf16 v[16:31], v[48:51], v[192:195], v[16:31]
    ds_read_b64_tr_b16 v[64:65], v12 offset:0
    ds_read_b64_tr_b16 v[66:67], v12 offset:512
    ds_read_b64_tr_b16 v[68:69], v13 offset:0
    ds_read_b64_tr_b16 v[70:71], v13 offset:512
    v_mfma_f32_32x32x16_bf16 v[32:47], v[52:55], v[192:195], v[32:47]
    ds_read_b64_tr_b16 v[72:73], v12 offset:2048
    ds_read_b64_tr_b16 v[74:75], v12 offset:2560
    ds_read_b64_tr_b16 v[76:77], v13 offset:2048
    ds_read_b64_tr_b16 v[78:79], v13 offset:2560
    v_mfma_f32_32x32x16_bf16 v[16:31], v[56:59], v[196:199], v[16:31]
    v_mfma_f32_32x32x16_bf16 v[32:47], v[60:63], v[196:199], v[32:47]
    s_waitcnt vmcnt(14)
    v_add_u32 v12, 16384, v2
    v_add_u32 v13, 16384, v11
    s_waitcnt lgkmcnt(0)
    v_mfma_f32_32x32x16_bf16 v[16:31], v[64:67], v[200:203], v[16:31]
    ds_read_b64_tr_b16 v[48:49], v12 offset:0
    ds_read_b64_tr_b16 v[50:51], v12 offset:512
    ds_read_b64_tr_b16 v[52:53], v13 offset:0
    ds_read_b64_tr_b16 v[54:55], v13 offset:512
    v_mfma_f32_32x32x16_bf16 v[32:47], v[68:71], v[200:203], v[32:47]
    ds_read_b64_tr_b16 v[56:57], v12 offset:2048
    ds_read_b64_tr_b16 v[58:59], v12 offset:2560
    ds_read_b64_tr_b16 v[60:61], v13 offset:2048
    ds_read_b64_tr_b16 v[62:63], v13 offset:2560
    v_mfma_f32_32x32x16_bf16 v[16:31], v[72:75], v[204:207], v[16:31]
    v_mfma_f32_32x32x16_bf16 v[32:47], v[76:79], v[204:207], v[32:47]
    s_waitcnt vmcnt(0)
    s_barrier
    v_add_u32 v12, 32768, v2
    v_add_u32 v13, 32768, v11
    s_waitcnt lgkmcnt(0)
    v_mfma_f32_32x32x16_bf16 v[16:31], v[48:51], v[208:211], v[16:31]
    ds_read_b64_tr_b16 v[64:65], v12 offset:0
    ds_read_b64_tr_b16 v[66:67], v12 offset:512
    ds_read_b64_tr_b16 v[68:69], v13 offset:0
    ds_read_b64_tr_b16 v[70:71], v13 offset:512
    v_mfma_f32_32x32x16_bf16 v[32:47], v[52:55], v[208:211], v[32:47]
    ds_read_b64_tr_b16 v[72:73], v12 offset:2048
    ds_read_b64_tr_b16 v[74:75], v12 offset:2560
    ds_read_b64_tr_b16 v[76:77], v13 offset:2048
    ds_read_b64_tr_b16 v[78:79], v13 offset:2560
    v_mfma_f32_32x32x16_bf16 v[16:31], v[56:59], v[212:215], v[16:31]
    v_mfma_f32_32x32x16_bf16 v[32:47], v[60:63], v[212:215], v[32:47]
    v_add_u32 v12, 49152, v2
    v_add_u32 v13, 49152, v11
    s_waitcnt lgkmcnt(0)
    v_mfma_f32_32x32x16_bf16 v[16:31], v[64:67], v[216:219], v[16:31]
    ds_read_b64_tr_b16 v[48:49], v12 offset:0
    ds_read_b64_tr_b16 v[50:51], v12 offset:512
    ds_read_b64_tr_b16 v[52:53], v13 offset:0
    ds_read_b64_tr_b16 v[54:55], v13 offset:512
    v_mfma_f32_32x32x16_bf16 v[32:47], v[68:71], v[216:219], v[32:47]
    ds_read_b64_tr_b16 v[56:57], v12 offset:2048
    ds_read_b64_tr_b16 v[58:59], v12 offset:2560
    ds_read_b64_tr_b16 v[60:61], v13 offset:2048
    ds_read_b64_tr_b16 v[62:63], v13 offset:2560
    v_mfma_f32_32x32x16_bf16 v[16:31], v[72:75], v[220:223], v[16:31]
    v_mfma_f32_32x32x16_bf16 v[32:47], v[76:79], v[220:223], v[32:47]
    v_add_u32 v12, 65536, v2
    v_add_u32 v13, 65536, v11
    s_waitcnt lgkmcnt(0)
    v_mfma_f32_32x32x16_bf16 v[16:31], v[48:51], v[224:227], v[16:31]
    ds_read_b64_tr_b16 v[64:65], v12 offset:0
    ds_read_b64_tr_b16 v[66:67], v12 offset:512
    ds_read_b64_tr_b16 v[68:69], v13 offset:0
    ds_read_b64_tr_b16 v[70:71], v13 offset:512
    v_mfma_f32_32x32x16_bf16 v[32:47], v[52:55], v[224:227], v[32:47]
    ds_read_b64_tr_b16 v[72:73], v12 offset:2048
    ds_read_b64_tr_b16 v[74:75], v12 offset:2560
    ds_read_b64_tr_b16 v[76:77], v13 offset:2048
    ds_read_b64_tr_b16 v[78:79], v13 offset:2560
    v_mfma_f32_32x32x16_bf16 v[16:31], v[56:59], v[228:231], v[16:31]
    v_mfma_f32_32x32x16_bf16 v[32:47], v[60:63], v[228:231], v[32:47]
    s_waitcnt lgkmcnt(0)
    v_mfma_f32_32x32x16_bf16 v[16:31], v[64:67], v[232:235], v[16:31]
    v_mfma_f32_32x32x16_bf16 v[32:47], v[68:71], v[232:235], v[32:47]
    v_mfma_f32_32x32x16_bf16 v[16:31], v[72:75], v[236:239], v[16:31]
    v_mfma_f32_32x32x16_bf16 v[32:47], v[76:79], v[236:239], v[32:47]
    s_cmp_eq_u32 s17, 0
    s_cbranch_scc1 L_own_55
    s_nop 8
    ds_write_b128 v92, v[16:19] offset:0
    ds_write_b128 v92, v[20:23] offset:1024
    s_branch L_ownd_56
L_own_55:
    s_nop 8
    v_mov_b32 v84, v16
    v_mov_b32 v85, v17
    v_mov_b32 v86, v18
    v_mov_b32 v87, v19
    v_mov_b32 v88, v20
    v_mov_b32 v89, v21
    v_mov_b32 v90, v22
    v_mov_b32 v91, v23
L_ownd_56:
    s_cmp_eq_u32 s17, 1
    s_cbranch_scc1 L_own_57
    ds_write_b128 v92, v[24:27] offset:2048
    ds_write_b128 v92, v[28:31] offset:3072
    s_branch L_ownd_58
L_own_57:
    v_mov_b32 v84, v24
    v_mov_b32 v85, v25
    v_mov_b32 v86, v26
    v_mov_b32 v87, v27
    v_mov_b32 v88, v28
    v_mov_b32 v89, v29
    v_mov_b32 v90, v30
    v_mov_b32 v91, v31
L_ownd_58:
    s_cmp_eq_u32 s17, 2
    s_cbranch_scc1 L_own_59
    ds_write_b128 v92, v[32:35] offset:4096
    ds_write_b128 v92, v[36:39] offset:5120
    s_branch L_ownd_60
L_own_59:
    v_mov_b32 v84, v32
    v_mov_b32 v85, v33
    v_mov_b32 v86, v34
    v_mov_b32 v87, v35
    v_mov_b32 v88, v36
    v_mov_b32 v89, v37
    v_mov_b32 v90, v38
    v_mov_b32 v91, v39
L_ownd_60:
    s_cmp_eq_u32 s17, 3
    s_cbranch_scc1 L_own_61
    ds_write_b128 v92, v[40:43] offset:6144
    ds_write_b128 v92, v[44:47] offset:7168
    s_branch L_ownd_62
L_own_61:
    v_mov_b32 v84, v40
    v_mov_b32 v85, v41
    v_mov_b32 v86, v42
    v_mov_b32 v87, v43
    v_mov_b32 v88, v44
    v_mov_b32 v89, v45
    v_mov_b32 v90, v46
    v_mov_b32 v91, v47
L_ownd_62:
    ds_read_b64_tr_b16 v[100:101], v96
    ds_read_b64_tr_b16 v[102:103], v96 offset:1024
    s_waitcnt lgkmcnt(0)
    s_barrier
    ds_read_b128 v[48:51], v93 offset:0
    ds_read_b128 v[52:55], v93 offset:1024
    ds_read_b128 v[56:59], v94 offset:0
    ds_read_b128 v[60:63], v94 offset:1024
    ds_read_b128 v[64:67], v95 offset:0
    ds_read_b128 v[68:71], v95 offset:1024
    v_lshlrev_b32 v72, 16, v100
    v_and_b32 v73, 0xffff0000, v100
    v_lshlrev_b32 v74, 16, v101
    v_and_b32 v75, 0xffff0000, v101
    v_lshlrev_b32 v76, 16, v102
    v_and_b32 v77, 0xffff0000, v102
    v_lshlrev_b32 v78, 16, v103
    v_and_b32 v79, 0xffff0000, v103
    v_add_f32 v84, v84, v72
    v_add_f32 v85, v85, v73
    v_add_f32 v86, v86, v74
    v_add_f32 v87, v87, v75
    v_add_f32 v88, v88, v76
    v_add_f32 v89, v89, v77
    v_add_f32 v90, v90, v78
    v_add_f32 v91, v91, v79
    s_waitcnt lgkmcnt(2)
    v_add_f32 v48, v48, v56
    v_add_f32 v49, v49, v57
    v_add_f32 v50, v50, v58
    v_add_f32 v51, v51, v59
    v_add_f32 v52, v52, v60
    v_add_f32 v53, v53, v61
    v_add_f32 v54, v54, v62
    v_add_f32 v55, v55, v63
    v_add_f32 v84, v84, v48
    v_add_f32 v85, v85, v49
    v_add_f32 v86, v86, v50
    v_add_f32 v87, v87, v51
    v_add_f32 v88, v88, v52
    v_add_f32 v89, v89, v53
    v_add_f32 v90, v90, v54
    v_add_f32 v91, v91, v55
    s_waitcnt lgkmcnt(0)
    v_add_f32 v84, v84, v64
    v_add_f32 v85, v85, v65
    v_add_f32 v86, v86, v66
    v_add_f32 v87, v87, v67
    v_add_f32 v88, v88, v68
    v_add_f32 v89, v89, v69
    v_add_f32 v90, v90, v70
    v_add_f32 v91, v91, v71
    v_cvt_pk_bf16_f32 v104, v84, v85
    v_cvt_pk_bf16_f32 v105, v86, v87
    v_cvt_pk_bf16_f32 v106, v88, v89
    v_cvt_pk_bf16_f32 v107, v90, v91
    s_nop 0
    v_permlane32_swap_b32 v104, v106
    v_permlane32_swap_b32 v105, v107
    buffer_store_dwordx4 v[104:107], v97, s[12:15], s57 offen
L_end:
    s_endpgm
.section .rodata,"a"
.p2align 6
.amdhsa_kernel sequential_preLN__ssm_conv_s4d__geglu_ffn__prompt_kernel
  .amdhsa_next_free_vgpr 256
  .amdhsa_next_free_sgpr 102
  .amdhsa_accum_offset 256
  .amdhsa_group_segment_fixed_size 0
  .amdhsa_kernarg_size 112
  .amdhsa_user_sgpr_count 2
  .amdhsa_user_sgpr_kernarg_segment_ptr 1
  .amdhsa_system_sgpr_workgroup_id_x 1
.end_amdhsa_kernel
```
